```python
import torch

def _softmax(x, axis=-1):
    return torch.softmax(x, dim=axis)
def _gelu(x):
    return torch.nn.functional.gelu(x, approximate="tanh")
def _silu(x):
    return torch.nn.functional.silu(x)
def _sigmoid(x):
    return torch.sigmoid(x)
def _layernorm(x, axis=-1, eps=1e-5):
    m = x.mean(dim=axis, keepdim=True)
    v = x.var(dim=axis, keepdim=True, unbiased=False)
    return (x - m) / torch.sqrt(v + eps)
def _scatter_add(tgt, idx, src, axis=0):
    return tgt.clone().index_add_(axis, idx, src)
def _segment_sum(src, seg, n):
    out = torch.zeros((n,) + src.shape[1:], dtype=src.dtype)
    return out.index_add_(0, seg, src)
def _pad(x, pw):
    flat = tuple(v for pair in reversed(pw) for v in pair)
    return torch.nn.functional.pad(x, flat)

kernel_name = 'concat_heads__mha_block_cached__mha_block_cached__near_ridge'

def setup_inputs():

    _w = (lambda a: (lambda t: t.to(torch.bfloat16) if t.is_floating_point() else t)(torch.as_tensor(a)))
    def _A_setup():
        B, Sq, D = 8, 160, 1024
        H, Sk, Dh = 32, 512, 128
        return {
            "x": _w((lambda *s: torch.randn(*s, dtype=torch.bfloat16) * 0.8)(B, Sq, D)),
            "k_cache": _w((lambda *s: torch.randn(*s, dtype=torch.bfloat16) * 0.8)(B, H, Sk, Dh)),
            "v_cache": _w((lambda *s: torch.randn(*s, dtype=torch.bfloat16) * 0.05)(B, H, Sk, Dh)),
            "wq": _w((lambda *s: torch.randn(*s, dtype=torch.bfloat16) * 0.8)(D, H * Dh) * (D ** -0.5)),
            "wo": _w((lambda *s: torch.randn(*s, dtype=torch.bfloat16) * 0.05)(H * Dh, D) * ((H * Dh) ** -0.5)),
        }
    _A_in = _A_setup()

    def _B_setup():
        B, Sq, D = 8, 160, 1024
        H, Sk, Dh = 32, 512, 128
        return {
            "x": _w((lambda *s: torch.randn(*s, dtype=torch.bfloat16) * 0.8)(B, Sq, D)),
            "k_cache": _w((lambda *s: torch.randn(*s, dtype=torch.bfloat16) * 0.8)(B, H, Sk, Dh)),
            "v_cache": _w((lambda *s: torch.randn(*s, dtype=torch.bfloat16) * 0.05)(B, H, Sk, Dh)),
            "wq": _w((lambda *s: torch.randn(*s, dtype=torch.bfloat16) * 0.8)(D, H * Dh) * (D ** -0.5)),
            "wo": _w((lambda *s: torch.randn(*s, dtype=torch.bfloat16) * 0.05)(H * Dh, D) * ((H * Dh) ** -0.5)),
        }
    _B_in = _B_setup()

    return {
        "A_x": _A_in["x"],
        "A_k_cache": _A_in["k_cache"],
        "A_v_cache": _A_in["v_cache"],
        "A_wq": _A_in["wq"],
        "A_wo": _A_in["wo"],
        "B_x": _B_in["x"],
        "B_k_cache": _B_in["k_cache"],
        "B_v_cache": _B_in["v_cache"],
        "B_wq": _B_in["wq"],
        "B_wo": _B_in["wo"],
    }

def reference(A_x, A_k_cache, A_v_cache, A_wq, A_wo, B_x, B_k_cache, B_v_cache, B_wq, B_wo):
    def _A_ref(x, k_cache, v_cache, wq, wo):
        B, Sq, D = x.shape
        H, Dh = 32, 128
        q = (lambda x, *d: x.permute(*d))((x @ wq).reshape(B, Sq, H, Dh), 0, 2, 1, 3)
        scores = torch.einsum("bhqd,bhkd->bhqk", q, k_cache) * (Dh ** -0.5)
        p = _softmax(scores, axis=-1)
        o = torch.einsum("bhqk,bhkd->bhqd", p, v_cache)
        return (lambda x, *d: x.permute(*d))(o, 0, 2, 1, 3).reshape(B, Sq, H * Dh) @ wo

    def _B_ref(x, k_cache, v_cache, wq, wo):
        B, Sq, D = x.shape
        H, Dh = 32, 128
        q = (lambda x, *d: x.permute(*d))((x @ wq).reshape(B, Sq, H, Dh), 0, 2, 1, 3)
        scores = torch.einsum("bhqd,bhkd->bhqk", q, k_cache) * (Dh ** -0.5)
        p = _softmax(scores, axis=-1)
        o = torch.einsum("bhqk,bhkd->bhqd", p, v_cache)
        return (lambda x, *d: x.permute(*d))(o, 0, 2, 1, 3).reshape(B, Sq, H * Dh) @ wo

    a = _A_ref(A_x, A_k_cache, A_v_cache, A_wq, A_wo)
    b = _B_ref(B_x, B_k_cache, B_v_cache, B_wq, B_wo)
    return torch.concatenate([a, b], axis=-1)
```

```asm
; @launch grid=(256,1,1) block=(256,1,1) lds=163840
.amdgcn_target "amdgcn-amd-amdhsa--gfx950"
.text
.globl concat_heads__mha_block_cached__mha_block_cached__near_ridge_kernel
.p2align 8
.type concat_heads__mha_block_cached__mha_block_cached__near_ridge_kernel,@function
concat_heads__mha_block_cached__mha_block_cached__near_ridge_kernel:
    s_cmp_ge_u32 s2, 256
    s_cbranch_scc1 Lexit1
    s_load_dwordx16 s[64:79], s[0:1], 0
    s_load_dwordx8 s[80:87], s[0:1], 64
    s_load_dwordx2 s[88:89], s[0:1], 96
    v_lshrrev_b32 v1, 6, v0
    v_and_b32 v0, 63, v0
    v_readfirstlane_b32 s4, v1
    s_bfe_u32 s48, s2, 0x10002
    s_lshr_b32 s49, s2, 5
    s_and_b32 s50, s2, 3
    s_lshl_b32 s50, s50, 2
    s_bfe_u32 s63, s2, 0x20003
    s_add_u32 s50, s50, s63
    s_and_b32 s5, s4, 1
    s_lshr_b32 s6, s4, 1
    s_lshr_b32 s51, s50, 3
    s_and_b32 s52, s50, 7
    v_lshrrev_b32 v26, 3, v0
    v_lshrrev_b32 v27, 4, v0
    v_xor_b32 v27, v27, v0
    v_and_b32 v27, 7, v27
    v_lshlrev_b32 v26, 11, v26
    v_lshl_add_u32 v26, v27, 4, v26
    s_mul_i32 s61, s4, 81920
    s_lshl_b32 s62, s5, 6
    v_xor_b32 v26, s62, v26
    v_add_u32 v192, s61, v26
    v_xor_b32 v27, 64, v192
    v_add_u32 v193, 15360, v27
    v_add_u32 v194, 30720, v192
    v_add_u32 v195, 46080, v27
    v_add_u32 v196, 65536, v192
    v_lshrrev_b32 v26, 5, v0
    v_and_b32 v27, 31, v0
    v_lshlrev_b32 v28, 1, v26
    v_xor_b32 v27, v27, v28
    v_lshlrev_b32 v26, 13, v26
    v_lshl_add_u32 v26, v27, 4, v26
    s_lshl_b32 s61, s4, 17
    v_add_u32 v197, s61, v26
    v_xor_b32 v26, 64, v197
    v_xor_b32 v27, 128, v197
    v_xor_b32 v28, 192, v197
    v_add_u32 v198, 15360, v26
    v_add_u32 v199, 30720, v197
    v_add_u32 v200, 46080, v26
    v_add_u32 v201, 65536, v27
    v_add_u32 v202, 80896, v28
    v_add_u32 v203, 96256, v27
    v_add_u32 v204, 111616, v28
    s_waitcnt lgkmcnt(0)
    s_cmp_eq_u32 s48, 0
    s_cselect_b64 s[64:65], s[64:65], s[74:75]
    s_cselect_b64 s[66:67], s[66:67], s[76:77]
    s_cselect_b64 s[68:69], s[68:69], s[78:79]
    s_cselect_b64 s[70:71], s[70:71], s[80:81]
    s_cselect_b64 s[72:73], s[72:73], s[82:83]
    s_mul_i32 s61, s49, 327680
    s_add_u32 s8, s64, s61
    s_addc_u32 s9, s65, 0
    s_mov_b32 s10, 327680
    s_mov_b32 s11, 0x20000
    s_lshl_b32 s61, s50, 9
    s_sub_u32 s62, 8388608, s61
    s_add_u32 s12, s70, s61
    s_addc_u32 s13, s71, 0
    s_mov_b32 s14, s62
    s_mov_b32 s15, 0x20000
    s_mov_b32 s53, 0
    s_mov_b32 s54, 0
    s_mul_i32 s90, s4, 5120
    s_lshl_b32 s91, s4, 13
    s_add_u32 s61, s53, s54
    s_xor_b32 s61, s61, s53
    s_and_b32 s61, s61, 1
    s_xor_b32 s61, s61, s53
    s_lshl_b32 s55, s61, 7
    s_lshl_b32 s56, s61, 19
    s_add_u32 s53, s53, 1
    s_add_u32 s60, s90, 139264
    s_add_u32 s59, s91, 32768
    s_add_u32 m0, s59, 0
    s_nop 0
    buffer_load_dwordx4 v197, s[12:15], s56 offen offset:0 lds
    buffer_load_dwordx4 v198, s[12:15], s56 offen offset:1024 lds
    buffer_load_dwordx4 v199, s[12:15], s56 offen offset:2048 lds
    buffer_load_dwordx4 v200, s[12:15], s56 offen offset:3072 lds
    s_add_u32 m0, s59, 4096
    s_nop 0
    buffer_load_dwordx4 v201, s[12:15], s56 offen offset:0 lds
    buffer_load_dwordx4 v202, s[12:15], s56 offen offset:1024 lds
    buffer_load_dwordx4 v203, s[12:15], s56 offen offset:2048 lds
    buffer_load_dwordx4 v204, s[12:15], s56 offen offset:3072 lds
    s_add_u32 m0, s60, 0
    s_nop 0
    buffer_load_dwordx4 v192, s[8:11], s55 offen offset:0 lds
    buffer_load_dwordx4 v193, s[8:11], s55 offen offset:1024 lds
    buffer_load_dwordx4 v194, s[8:11], s55 offen offset:2048 lds
    buffer_load_dwordx4 v195, s[8:11], s55 offen offset:3072 lds
    s_add_u32 m0, s60, 4096
    s_nop 0
    buffer_load_dwordx4 v196, s[8:11], s55 offen offset:0 lds
    v_and_b32 v26, 15, v0
    s_mul_i32 s61, s5, 80
    v_add_u32 v26, s61, v26
    v_lshlrev_b32 v26, 7, v26
    v_lshrrev_b32 v27, 4, v0
    v_bfe_u32 v28, v0, 1, 3
    v_xor_b32 v28, v27, v28
    v_lshl_add_u32 v215, v28, 4, v26
    v_xor_b32 v216, 64, v215
    v_bfe_u32 v26, v0, 2, 2
    v_lshl_add_u32 v28, v27, 3, v26
    v_lshlrev_b32 v28, 9, v28
    v_and_b32 v29, 3, v0
    v_lshl_add_u32 v28, v29, 3, v28
    s_lshl_b32 s61, s6, 8
    v_add_u32 v28, s61, v28
    v_and_b32 v27, 1, v27
    v_lshl_add_u32 v26, v27, 2, v26
    v_lshl_add_u32 v217, v26, 5, v28
    v_xor_b32 v218, 32, v217
    v_xor_b32 v219, 64, v217
    v_xor_b32 v220, 96, v217
    v_xor_b32 v221, 128, v217
    v_xor_b32 v222, 160, v217
    v_xor_b32 v223, 192, v217
    v_xor_b32 v224, 224, v217
    v_add_u32 v205, 139264, v215
    v_add_u32 v206, 139264, v216
    v_add_u32 v207, 32768, v217
    v_add_u32 v208, 32768, v218
    v_add_u32 v209, 32768, v219
    v_add_u32 v210, 32768, v220
    v_add_u32 v211, 32768, v221
    v_add_u32 v212, 32768, v222
    v_add_u32 v213, 32768, v223
    v_add_u32 v214, 32768, v224
    v_mov_b64 v[32:33], 0
    v_mov_b64 v[34:35], 0
    v_mov_b64 v[36:37], 0
    v_mov_b64 v[38:39], 0
    v_mov_b64 v[40:41], 0
    v_mov_b64 v[42:43], 0
    v_mov_b64 v[44:45], 0
    v_mov_b64 v[46:47], 0
    v_mov_b64 v[48:49], 0
    v_mov_b64 v[50:51], 0
    v_mov_b64 v[52:53], 0
    v_mov_b64 v[54:55], 0
    v_mov_b64 v[56:57], 0
    v_mov_b64 v[58:59], 0
    v_mov_b64 v[60:61], 0
    v_mov_b64 v[62:63], 0
    v_mov_b64 v[64:65], 0
    v_mov_b64 v[66:67], 0
    v_mov_b64 v[68:69], 0
    v_mov_b64 v[70:71], 0
    v_mov_b64 v[72:73], 0
    v_mov_b64 v[74:75], 0
    v_mov_b64 v[76:77], 0
    v_mov_b64 v[78:79], 0
    v_mov_b64 v[80:81], 0
    v_mov_b64 v[82:83], 0
    v_mov_b64 v[84:85], 0
    v_mov_b64 v[86:87], 0
    v_mov_b64 v[88:89], 0
    v_mov_b64 v[90:91], 0
    v_mov_b64 v[92:93], 0
    v_mov_b64 v[94:95], 0
    v_mov_b64 v[96:97], 0
    v_mov_b64 v[98:99], 0
    v_mov_b64 v[100:101], 0
    v_mov_b64 v[102:103], 0
    v_mov_b64 v[104:105], 0
    v_mov_b64 v[106:107], 0
    v_mov_b64 v[108:109], 0
    v_mov_b64 v[110:111], 0
    v_mov_b64 v[112:113], 0
    v_mov_b64 v[114:115], 0
    v_mov_b64 v[116:117], 0
    v_mov_b64 v[118:119], 0
    v_mov_b64 v[120:121], 0
    v_mov_b64 v[122:123], 0
    v_mov_b64 v[124:125], 0
    v_mov_b64 v[126:127], 0
    v_mov_b64 v[128:129], 0
    v_mov_b64 v[130:131], 0
    v_mov_b64 v[132:133], 0
    v_mov_b64 v[134:135], 0
    v_mov_b64 v[136:137], 0
    v_mov_b64 v[138:139], 0
    v_mov_b64 v[140:141], 0
    v_mov_b64 v[142:143], 0
    v_mov_b64 v[144:145], 0
    v_mov_b64 v[146:147], 0
    v_mov_b64 v[148:149], 0
    v_mov_b64 v[150:151], 0
    v_mov_b64 v[152:153], 0
    v_mov_b64 v[154:155], 0
    v_mov_b64 v[156:157], 0
    v_mov_b64 v[158:159], 0
    v_mov_b64 v[160:161], 0
    v_mov_b64 v[162:163], 0
    v_mov_b64 v[164:165], 0
    v_mov_b64 v[166:167], 0
    v_mov_b64 v[168:169], 0
    v_mov_b64 v[170:171], 0
    v_mov_b64 v[172:173], 0
    v_mov_b64 v[174:175], 0
    v_mov_b64 v[176:177], 0
    v_mov_b64 v[178:179], 0
    v_mov_b64 v[180:181], 0
    v_mov_b64 v[182:183], 0
    v_mov_b64 v[184:185], 0
    v_mov_b64 v[186:187], 0
    v_mov_b64 v[188:189], 0
    v_mov_b64 v[190:191], 0
    s_lshl_b32 s61, s51, 22
    s_lshl_b32 s62, s52, 8
    s_add_u32 s61, s61, s62
    s_sub_u32 s62, 4194304, s62
    s_add_u32 s28, s72, s61
    s_addc_u32 s29, s73, 0
    s_mov_b32 s30, s62
    s_mov_b32 s31, 0x20000
    v_lshrrev_b32 v225, 1, v0
    v_and_b32 v226, 1, v0
    v_lshlrev_b32 v225, 11, v225
    v_lshl_add_u32 v225, v226, 7, v225
    s_lshl2_add_u32 s75, s49, s4
    s_lshl_b32 s75, s75, 17
    s_lshr_b32 s61, s2, 3
    s_and_b32 s61, s61, 0
    s_lshl_b32 s3, 21760, s61
    v_and_b32 v226, 32, v0
    v_lshl_add_u32 v225, v226, 24, v225
    s_add_u32 s61, s53, s54
    s_xor_b32 s61, s61, s53
    s_and_b32 s61, s61, 1
    s_xor_b32 s61, s61, s53
    s_lshl_b32 s55, s61, 7
    s_lshl_b32 s56, s61, 19
    s_add_u32 s53, s53, 1
    s_add_u32 s60, s90, 98304
    s_add_u32 s59, s91, 65536
    s_add_u32 m0, s59, 0
    s_nop 0
    buffer_load_dwordx4 v197, s[12:15], s56 offen offset:0 lds
    buffer_load_dwordx4 v198, s[12:15], s56 offen offset:1024 lds
    buffer_load_dwordx4 v199, s[12:15], s56 offen offset:2048 lds
    buffer_load_dwordx4 v200, s[12:15], s56 offen offset:3072 lds
    s_add_u32 m0, s59, 4096
    s_nop 0
    buffer_load_dwordx4 v201, s[12:15], s56 offen offset:0 lds
    buffer_load_dwordx4 v202, s[12:15], s56 offen offset:1024 lds
    buffer_load_dwordx4 v203, s[12:15], s56 offen offset:2048 lds
    buffer_load_dwordx4 v204, s[12:15], s56 offen offset:3072 lds
    s_add_u32 m0, s60, 0
    s_nop 0
    buffer_load_dwordx4 v192, s[8:11], s55 offen offset:0 lds
    buffer_load_dwordx4 v193, s[8:11], s55 offen offset:1024 lds
    buffer_load_dwordx4 v194, s[8:11], s55 offen offset:2048 lds
    buffer_load_dwordx4 v195, s[8:11], s55 offen offset:3072 lds
    s_add_u32 m0, s60, 4096
    s_nop 0
    buffer_load_dwordx4 v196, s[8:11], s55 offen offset:0 lds
    s_add_u32 s54, s50, s49
    s_waitcnt vmcnt(13)
    s_barrier
    ds_read_b128 a[104:107], v205 offset:0
    ds_read_b128 a[108:111], v206 offset:0
    ds_read_b64_tr_b16 a[0:1], v207 offset:0
    ds_read_b64_tr_b16 a[2:3], v207 offset:2048
    ds_read_b64_tr_b16 a[4:5], v207 offset:16384
    ds_read_b64_tr_b16 a[6:7], v207 offset:18432
    ds_read_b128 a[112:115], v205 offset:2048
    ds_read_b128 a[116:119], v206 offset:2048
    ds_read_b128 a[120:123], v205 offset:4096
    ds_read_b128 a[124:127], v206 offset:4096
    ds_read_b128 a[128:131], v205 offset:6144
    ds_read_b128 a[132:135], v206 offset:6144
    ds_read_b128 a[136:139], v205 offset:8192
    ds_read_b128 a[140:143], v206 offset:8192
    ds_read_b64_tr_b16 a[8:9], v208 offset:0
    ds_read_b64_tr_b16 a[10:11], v208 offset:2048
    ds_read_b64_tr_b16 a[12:13], v208 offset:16384
    ds_read_b64_tr_b16 a[14:15], v208 offset:18432
    s_add_u32 s61, s53, s54
    s_xor_b32 s61, s61, s53
    s_and_b32 s61, s61, 1
    s_xor_b32 s61, s61, s53
    s_lshl_b32 s55, s61, 7
    s_lshl_b32 s56, s61, 19
    s_add_u32 s53, s53, 1
    s_add_u32 s60, s90, 118784
    s_add_u32 s59, s91, 0
    s_add_u32 m0, s59, 0
    s_mov_b32 s58, 98304
    s_mov_b32 s57, 65536
    s_waitcnt lgkmcnt(14)
    v_mfma_f32_16x16x32_bf16 v[32:35], a[0:3], a[104:107], v[32:35]
    ds_read_b64_tr_b16 a[16:17], v209 offset:0
    s_waitcnt lgkmcnt(13)
    v_mfma_f32_16x16x32_bf16 v[32:35], a[4:7], a[108:111], v[32:35]
    ds_read_b64_tr_b16 a[18:19], v209 offset:2048
    ds_read_b64_tr_b16 a[20:21], v209 offset:16384
    s_waitcnt lgkmcnt(14)
    v_mfma_f32_16x16x32_bf16 v[64:67], a[0:3], a[112:115], v[64:67]
    ds_read_b64_tr_b16 a[22:23], v209 offset:18432
    ds_read_b64_tr_b16 a[24:25], v210 offset:0
    s_waitcnt lgkmcnt(15)
    v_mfma_f32_16x16x32_bf16 v[64:67], a[4:7], a[116:119], v[64:67]
    ds_read_b64_tr_b16 a[26:27], v210 offset:2048
    ds_read_b64_tr_b16 a[28:29], v210 offset:16384
    s_waitcnt lgkmcnt(15)
    v_mfma_f32_16x16x32_bf16 v[96:99], a[0:3], a[120:123], v[96:99]
    ds_read_b64_tr_b16 a[30:31], v210 offset:18432
    ds_read_b64_tr_b16 a[32:33], v211 offset:0
    v_mfma_f32_16x16x32_bf16 v[96:99], a[4:7], a[124:127], v[96:99]
    ds_read_b64_tr_b16 a[34:35], v211 offset:2048
    ds_read_b64_tr_b16 a[36:37], v211 offset:16384
    s_waitcnt lgkmcnt(15)
    v_mfma_f32_16x16x32_bf16 v[128:131], a[0:3], a[128:131], v[128:131]
    ds_read_b64_tr_b16 a[38:39], v211 offset:18432
    ds_read_b64_tr_b16 a[40:41], v212 offset:0
    buffer_load_dwordx4 v197, s[12:15], s56 offen offset:0 lds
    buffer_load_dwordx4 v198, s[12:15], s56 offen offset:1024 lds
    v_mfma_f32_16x16x32_bf16 v[128:131], a[4:7], a[132:135], v[128:131]
    ds_read_b64_tr_b16 a[42:43], v212 offset:2048
    ds_read_b64_tr_b16 a[44:45], v212 offset:16384
    buffer_load_dwordx4 v199, s[12:15], s56 offen offset:2048 lds
    v_mfma_f32_16x16x32_bf16 v[160:163], a[0:3], a[136:139], v[160:163]
    ds_read_b64_tr_b16 a[46:47], v212 offset:18432
    ds_read_b64_tr_b16 a[48:49], v213 offset:0
    buffer_load_dwordx4 v200, s[12:15], s56 offen offset:3072 lds
    v_mfma_f32_16x16x32_bf16 v[160:163], a[4:7], a[140:143], v[160:163]
    ds_read_b64_tr_b16 a[50:51], v213 offset:2048
    ds_read_b64_tr_b16 a[52:53], v213 offset:16384
    s_add_u32 m0, s59, 4096
    s_waitcnt lgkmcnt(15)
    v_mfma_f32_16x16x32_bf16 v[36:39], a[8:11], a[104:107], v[36:39]
    ds_read_b64_tr_b16 a[54:55], v213 offset:18432
    ds_read_b64_tr_b16 a[56:57], v214 offset:0
    buffer_load_dwordx4 v201, s[12:15], s56 offen offset:0 lds
    buffer_load_dwordx4 v202, s[12:15], s56 offen offset:1024 lds
    v_mfma_f32_16x16x32_bf16 v[36:39], a[12:15], a[108:111], v[36:39]
    ds_read_b64_tr_b16 a[58:59], v214 offset:2048
    ds_read_b64_tr_b16 a[60:61], v214 offset:16384
    ds_read_b64_tr_b16 a[62:63], v214 offset:18432
    v_mfma_f32_16x16x32_bf16 v[68:71], a[8:11], a[112:115], v[68:71]
    buffer_load_dwordx4 v203, s[12:15], s56 offen offset:2048 lds
    buffer_load_dwordx4 v204, s[12:15], s56 offen offset:3072 lds
    v_add_u32 v205, s58, v215
    v_mfma_f32_16x16x32_bf16 v[68:71], a[12:15], a[116:119], v[68:71]
    v_add_u32 v206, s58, v216
    v_add_u32 v207, s57, v217
    s_add_u32 m0, s60, 0
    v_mfma_f32_16x16x32_bf16 v[100:103], a[8:11], a[120:123], v[100:103]
    buffer_load_dwordx4 v192, s[8:11], s55 offen offset:0 lds
    buffer_load_dwordx4 v193, s[8:11], s55 offen offset:1024 lds
    v_add_u32 v208, s57, v218
    v_mfma_f32_16x16x32_bf16 v[100:103], a[12:15], a[124:127], v[100:103]
    buffer_load_dwordx4 v194, s[8:11], s55 offen offset:2048 lds
    v_add_u32 v209, s57, v219
    v_mfma_f32_16x16x32_bf16 v[132:135], a[8:11], a[128:131], v[132:135]
    buffer_load_dwordx4 v195, s[8:11], s55 offen offset:3072 lds
    v_add_u32 v210, s57, v220
    v_mfma_f32_16x16x32_bf16 v[132:135], a[12:15], a[132:135], v[132:135]
    v_add_u32 v211, s57, v221
    v_add_u32 v212, s57, v222
    s_add_u32 m0, s60, 4096
    v_mfma_f32_16x16x32_bf16 v[164:167], a[8:11], a[136:139], v[164:167]
    buffer_load_dwordx4 v196, s[8:11], s55 offen offset:0 lds
    v_add_u32 v213, s57, v223
    v_mfma_f32_16x16x32_bf16 v[164:167], a[12:15], a[140:143], v[164:167]
    v_add_u32 v214, s57, v224
    s_add_u32 s60, s90, 139264
    s_add_u32 s59, s91, 32768
Lq_loop:
    s_waitcnt vmcnt(13) lgkmcnt(0)
    s_barrier
    v_mfma_f32_16x16x32_bf16 v[40:43], a[16:19], a[104:107], v[40:43]
    ds_read_b64_tr_b16 a[0:1], v207 offset:0
    v_mfma_f32_16x16x32_bf16 v[40:43], a[20:23], a[108:111], v[40:43]
    ds_read_b64_tr_b16 a[2:3], v207 offset:2048
    s_add_u32 s61, s53, s54
    v_mfma_f32_16x16x32_bf16 v[72:75], a[16:19], a[112:115], v[72:75]
    ds_read_b128 a[64:67], v205 offset:0
    v_mfma_f32_16x16x32_bf16 v[72:75], a[20:23], a[116:119], v[72:75]
    ds_read_b64_tr_b16 a[4:5], v207 offset:16384
    v_mfma_f32_16x16x32_bf16 v[104:107], a[16:19], a[120:123], v[104:107]
    ds_read_b64_tr_b16 a[6:7], v207 offset:18432
    s_xor_b32 s61, s61, s53
    v_mfma_f32_16x16x32_bf16 v[104:107], a[20:23], a[124:127], v[104:107]
    ds_read_b64_tr_b16 a[8:9], v208 offset:0
    v_mfma_f32_16x16x32_bf16 v[136:139], a[16:19], a[128:131], v[136:139]
    ds_read_b64_tr_b16 a[10:11], v208 offset:2048
    v_mfma_f32_16x16x32_bf16 v[136:139], a[20:23], a[132:135], v[136:139]
    ds_read_b128 a[68:71], v206 offset:0
    v_mfma_f32_16x16x32_bf16 v[168:171], a[16:19], a[136:139], v[168:171]
    ds_read_b64_tr_b16 a[12:13], v208 offset:16384
    s_and_b32 s61, s61, 1
    v_mfma_f32_16x16x32_bf16 v[168:171], a[20:23], a[140:143], v[168:171]
    ds_read_b64_tr_b16 a[14:15], v208 offset:18432
    v_mfma_f32_16x16x32_bf16 v[44:47], a[24:27], a[104:107], v[44:47]
    v_mfma_f32_16x16x32_bf16 v[44:47], a[28:31], a[108:111], v[44:47]
    ds_read_b64_tr_b16 a[16:17], v209 offset:0
    s_xor_b32 s61, s61, s53
    v_mfma_f32_16x16x32_bf16 v[76:79], a[24:27], a[112:115], v[76:79]
    ds_read_b128 a[72:75], v205 offset:2048
    v_mfma_f32_16x16x32_bf16 v[76:79], a[28:31], a[116:119], v[76:79]
    ds_read_b64_tr_b16 a[18:19], v209 offset:2048
    v_mfma_f32_16x16x32_bf16 v[108:111], a[24:27], a[120:123], v[108:111]
    s_lshl_b32 s55, s61, 7
    v_mfma_f32_16x16x32_bf16 v[108:111], a[28:31], a[124:127], v[108:111]
    v_mfma_f32_16x16x32_bf16 v[140:143], a[24:27], a[128:131], v[140:143]
    ds_read_b64_tr_b16 a[20:21], v209 offset:16384
    v_mfma_f32_16x16x32_bf16 v[140:143], a[28:31], a[132:135], v[140:143]
    ds_read_b128 a[76:79], v206 offset:2048
    v_mfma_f32_16x16x32_bf16 v[172:175], a[24:27], a[136:139], v[172:175]
    ds_read_b64_tr_b16 a[22:23], v209 offset:18432
    s_lshl_b32 s56, s61, 19
    v_mfma_f32_16x16x32_bf16 v[172:175], a[28:31], a[140:143], v[172:175]
    v_mfma_f32_16x16x32_bf16 v[48:51], a[32:35], a[104:107], v[48:51]
    v_mfma_f32_16x16x32_bf16 v[48:51], a[36:39], a[108:111], v[48:51]
    ds_read_b64_tr_b16 a[24:25], v210 offset:0
    s_add_u32 s53, s53, 1
    v_mfma_f32_16x16x32_bf16 v[80:83], a[32:35], a[112:115], v[80:83]
    ds_read_b128 a[80:83], v205 offset:4096
    v_mfma_f32_16x16x32_bf16 v[80:83], a[36:39], a[116:119], v[80:83]
    ds_read_b64_tr_b16 a[26:27], v210 offset:2048
    v_mfma_f32_16x16x32_bf16 v[112:115], a[32:35], a[120:123], v[112:115]
    s_add_u32 m0, s59, 0
    v_mfma_f32_16x16x32_bf16 v[112:115], a[36:39], a[124:127], v[112:115]
    v_mfma_f32_16x16x32_bf16 v[144:147], a[32:35], a[128:131], v[144:147]
    ds_read_b64_tr_b16 a[28:29], v210 offset:16384
    v_mfma_f32_16x16x32_bf16 v[144:147], a[36:39], a[132:135], v[144:147]
    buffer_load_dwordx4 v197, s[12:15], s56 offen offset:0 lds
    v_mfma_f32_16x16x32_bf16 v[176:179], a[32:35], a[136:139], v[176:179]
    ds_read_b64_tr_b16 a[30:31], v210 offset:18432
    v_mfma_f32_16x16x32_bf16 v[176:179], a[36:39], a[140:143], v[176:179]
    ds_read_b128 a[84:87], v206 offset:4096
    v_mfma_f32_16x16x32_bf16 v[52:55], a[40:43], a[104:107], v[52:55]
    ds_read_b64_tr_b16 a[32:33], v211 offset:0
    v_mfma_f32_16x16x32_bf16 v[52:55], a[44:47], a[108:111], v[52:55]
    buffer_load_dwordx4 v198, s[12:15], s56 offen offset:1024 lds
    v_mfma_f32_16x16x32_bf16 v[84:87], a[40:43], a[112:115], v[84:87]
    ds_read_b128 a[88:91], v205 offset:6144
    v_mfma_f32_16x16x32_bf16 v[84:87], a[44:47], a[116:119], v[84:87]
    ds_read_b64_tr_b16 a[34:35], v211 offset:2048
    v_mfma_f32_16x16x32_bf16 v[116:119], a[40:43], a[120:123], v[116:119]
    buffer_load_dwordx4 v199, s[12:15], s56 offen offset:2048 lds
    v_mfma_f32_16x16x32_bf16 v[116:119], a[44:47], a[124:127], v[116:119]
    v_mfma_f32_16x16x32_bf16 v[148:151], a[40:43], a[128:131], v[148:151]
    ds_read_b64_tr_b16 a[36:37], v211 offset:16384
    v_mfma_f32_16x16x32_bf16 v[148:151], a[44:47], a[132:135], v[148:151]
    buffer_load_dwordx4 v200, s[12:15], s56 offen offset:3072 lds
    v_mfma_f32_16x16x32_bf16 v[180:183], a[40:43], a[136:139], v[180:183]
    ds_read_b64_tr_b16 a[38:39], v211 offset:18432
    v_mfma_f32_16x16x32_bf16 v[180:183], a[44:47], a[140:143], v[180:183]
    ds_read_b128 a[92:95], v206 offset:6144
    v_mfma_f32_16x16x32_bf16 v[56:59], a[48:51], a[104:107], v[56:59]
    v_mfma_f32_16x16x32_bf16 v[56:59], a[52:55], a[108:111], v[56:59]
    ds_read_b64_tr_b16 a[40:41], v212 offset:0
    s_add_u32 m0, s59, 4096
    v_mfma_f32_16x16x32_bf16 v[88:91], a[48:51], a[112:115], v[88:91]
    ds_read_b128 a[96:99], v205 offset:8192
    v_mfma_f32_16x16x32_bf16 v[88:91], a[52:55], a[116:119], v[88:91]
    ds_read_b64_tr_b16 a[42:43], v212 offset:2048
    v_mfma_f32_16x16x32_bf16 v[120:123], a[48:51], a[120:123], v[120:123]
    buffer_load_dwordx4 v201, s[12:15], s56 offen offset:0 lds
    v_mfma_f32_16x16x32_bf16 v[120:123], a[52:55], a[124:127], v[120:123]
    v_mfma_f32_16x16x32_bf16 v[152:155], a[48:51], a[128:131], v[152:155]
    ds_read_b64_tr_b16 a[44:45], v212 offset:16384
    v_mfma_f32_16x16x32_bf16 v[152:155], a[52:55], a[132:135], v[152:155]
    buffer_load_dwordx4 v202, s[12:15], s56 offen offset:1024 lds
    v_mfma_f32_16x16x32_bf16 v[184:187], a[48:51], a[136:139], v[184:187]
    ds_read_b64_tr_b16 a[46:47], v212 offset:18432
    s_add_u32 s82, s90, s58
    v_mfma_f32_16x16x32_bf16 v[184:187], a[52:55], a[140:143], v[184:187]
    ds_read_b128 a[100:103], v206 offset:8192
    v_mfma_f32_16x16x32_bf16 v[60:63], a[56:59], a[104:107], v[60:63]
    ds_read_b64_tr_b16 a[48:49], v213 offset:0
    s_add_u32 s100, s91, s57
    v_mfma_f32_16x16x32_bf16 v[60:63], a[60:63], a[108:111], v[60:63]
    buffer_load_dwordx4 v203, s[12:15], s56 offen offset:2048 lds
    v_mfma_f32_16x16x32_bf16 v[92:95], a[56:59], a[112:115], v[92:95]
    s_add_u32 s58, s58, 20480
    v_mfma_f32_16x16x32_bf16 v[92:95], a[60:63], a[116:119], v[92:95]
    ds_read_b64_tr_b16 a[50:51], v213 offset:2048
    v_mfma_f32_16x16x32_bf16 v[124:127], a[56:59], a[120:123], v[124:127]
    buffer_load_dwordx4 v204, s[12:15], s56 offen offset:3072 lds
    v_mfma_f32_16x16x32_bf16 v[124:127], a[60:63], a[124:127], v[124:127]
    s_cmp_gt_u32 s58, 139264
    s_cselect_b32 s58, 98304, s58
    v_mfma_f32_16x16x32_bf16 v[156:159], a[56:59], a[128:131], v[156:159]
    ds_read_b64_tr_b16 a[52:53], v213 offset:16384
    s_add_u32 s57, s57, 32768
    v_mfma_f32_16x16x32_bf16 v[156:159], a[60:63], a[132:135], v[156:159]
    s_add_u32 m0, s60, 0
    v_mfma_f32_16x16x32_bf16 v[188:191], a[56:59], a[136:139], v[188:191]
    ds_read_b64_tr_b16 a[54:55], v213 offset:18432
    v_mfma_f32_16x16x32_bf16 v[188:191], a[60:63], a[140:143], v[188:191]
    s_cmp_gt_u32 s57, 65536
    s_cselect_b32 s57, 0, s57
    s_waitcnt lgkmcnt(15)
    v_mfma_f32_16x16x32_bf16 v[32:35], a[0:3], a[64:67], v[32:35]
    buffer_load_dwordx4 v192, s[8:11], s55 offen offset:0 lds
    v_mfma_f32_16x16x32_bf16 v[32:35], a[4:7], a[68:71], v[32:35]
    ds_read_b64_tr_b16 a[56:57], v214 offset:0
    v_add_u32 v205, s58, v215
    v_mfma_f32_16x16x32_bf16 v[64:67], a[0:3], a[72:75], v[64:67]
    v_mfma_f32_16x16x32_bf16 v[64:67], a[4:7], a[76:79], v[64:67]
    ds_read_b64_tr_b16 a[58:59], v214 offset:2048
    v_add_u32 v206, s58, v216
    v_mfma_f32_16x16x32_bf16 v[96:99], a[0:3], a[80:83], v[96:99]
    buffer_load_dwordx4 v193, s[8:11], s55 offen offset:1024 lds
    v_mfma_f32_16x16x32_bf16 v[96:99], a[4:7], a[84:87], v[96:99]
    v_add_u32 v207, s57, v217
    s_waitcnt lgkmcnt(15)
    v_mfma_f32_16x16x32_bf16 v[128:131], a[0:3], a[88:91], v[128:131]
    ds_read_b64_tr_b16 a[60:61], v214 offset:16384
    v_add_u32 v208, s57, v218
    s_waitcnt lgkmcnt(13)
    v_mfma_f32_16x16x32_bf16 v[128:131], a[4:7], a[92:95], v[128:131]
    buffer_load_dwordx4 v194, s[8:11], s55 offen offset:2048 lds
    s_waitcnt lgkmcnt(11)
    v_mfma_f32_16x16x32_bf16 v[160:163], a[0:3], a[96:99], v[160:163]
    ds_read_b64_tr_b16 a[62:63], v214 offset:18432
    s_waitcnt lgkmcnt(8)
    v_mfma_f32_16x16x32_bf16 v[160:163], a[4:7], a[100:103], v[160:163]
    v_add_u32 v209, s57, v219
    v_mfma_f32_16x16x32_bf16 v[36:39], a[8:11], a[64:67], v[36:39]
    buffer_load_dwordx4 v195, s[8:11], s55 offen offset:3072 lds
    v_mfma_f32_16x16x32_bf16 v[36:39], a[12:15], a[68:71], v[36:39]
    v_add_u32 v210, s57, v220
    v_mfma_f32_16x16x32_bf16 v[68:71], a[8:11], a[72:75], v[68:71]
    v_mfma_f32_16x16x32_bf16 v[68:71], a[12:15], a[76:79], v[68:71]
    v_add_u32 v211, s57, v221
    v_mfma_f32_16x16x32_bf16 v[100:103], a[8:11], a[80:83], v[100:103]
    s_add_u32 m0, s60, 4096
    v_mfma_f32_16x16x32_bf16 v[100:103], a[12:15], a[84:87], v[100:103]
    v_add_u32 v212, s57, v222
    v_mfma_f32_16x16x32_bf16 v[132:135], a[8:11], a[88:91], v[132:135]
    v_mfma_f32_16x16x32_bf16 v[132:135], a[12:15], a[92:95], v[132:135]
    buffer_load_dwordx4 v196, s[8:11], s55 offen offset:0 lds
    v_mfma_f32_16x16x32_bf16 v[164:167], a[8:11], a[96:99], v[164:167]
    v_add_u32 v213, s57, v223
    v_add_u32 v214, s57, v224
    v_mfma_f32_16x16x32_bf16 v[164:167], a[12:15], a[100:103], v[164:167]
    s_mov_b32 s60, s82
    s_mov_b32 s59, s100
    s_bitcmp1_b32 s3, s53
    s_cbranch_scc0 Lg1
    buffer_load_dword v226, v225, s[28:31], s75 offen
    s_add_u32 s75, s75, 32768
Lg1:
    s_waitcnt vmcnt(13) lgkmcnt(0)
    s_barrier
    v_mfma_f32_16x16x32_bf16 v[40:43], a[16:19], a[64:67], v[40:43]
    ds_read_b64_tr_b16 a[0:1], v207 offset:0
    v_mfma_f32_16x16x32_bf16 v[40:43], a[20:23], a[68:71], v[40:43]
    ds_read_b64_tr_b16 a[2:3], v207 offset:2048
    s_add_u32 s61, s53, s54
    v_mfma_f32_16x16x32_bf16 v[72:75], a[16:19], a[72:75], v[72:75]
    ds_read_b128 a[104:107], v205 offset:0
    v_mfma_f32_16x16x32_bf16 v[72:75], a[20:23], a[76:79], v[72:75]
    ds_read_b64_tr_b16 a[4:5], v207 offset:16384
    v_mfma_f32_16x16x32_bf16 v[104:107], a[16:19], a[80:83], v[104:107]
    ds_read_b64_tr_b16 a[6:7], v207 offset:18432
    s_xor_b32 s61, s61, s53
    v_mfma_f32_16x16x32_bf16 v[104:107], a[20:23], a[84:87], v[104:107]
    ds_read_b64_tr_b16 a[8:9], v208 offset:0
    v_mfma_f32_16x16x32_bf16 v[136:139], a[16:19], a[88:91], v[136:139]
    ds_read_b64_tr_b16 a[10:11], v208 offset:2048
    v_mfma_f32_16x16x32_bf16 v[136:139], a[20:23], a[92:95], v[136:139]
    ds_read_b128 a[108:111], v206 offset:0
    v_mfma_f32_16x16x32_bf16 v[168:171], a[16:19], a[96:99], v[168:171]
    ds_read_b64_tr_b16 a[12:13], v208 offset:16384
    s_and_b32 s61, s61, 1
    v_mfma_f32_16x16x32_bf16 v[168:171], a[20:23], a[100:103], v[168:171]
    ds_read_b64_tr_b16 a[14:15], v208 offset:18432
    v_mfma_f32_16x16x32_bf16 v[44:47], a[24:27], a[64:67], v[44:47]
    v_mfma_f32_16x16x32_bf16 v[44:47], a[28:31], a[68:71], v[44:47]
    ds_read_b64_tr_b16 a[16:17], v209 offset:0
    s_xor_b32 s61, s61, s53
    v_mfma_f32_16x16x32_bf16 v[76:79], a[24:27], a[72:75], v[76:79]
    ds_read_b128 a[112:115], v205 offset:2048
    v_mfma_f32_16x16x32_bf16 v[76:79], a[28:31], a[76:79], v[76:79]
    ds_read_b64_tr_b16 a[18:19], v209 offset:2048
    v_mfma_f32_16x16x32_bf16 v[108:111], a[24:27], a[80:83], v[108:111]
    s_lshl_b32 s55, s61, 7
    v_mfma_f32_16x16x32_bf16 v[108:111], a[28:31], a[84:87], v[108:111]
    v_mfma_f32_16x16x32_bf16 v[140:143], a[24:27], a[88:91], v[140:143]
    ds_read_b64_tr_b16 a[20:21], v209 offset:16384
    v_mfma_f32_16x16x32_bf16 v[140:143], a[28:31], a[92:95], v[140:143]
    ds_read_b128 a[116:119], v206 offset:2048
    v_mfma_f32_16x16x32_bf16 v[172:175], a[24:27], a[96:99], v[172:175]
    ds_read_b64_tr_b16 a[22:23], v209 offset:18432
    s_lshl_b32 s56, s61, 19
    v_mfma_f32_16x16x32_bf16 v[172:175], a[28:31], a[100:103], v[172:175]
    v_mfma_f32_16x16x32_bf16 v[48:51], a[32:35], a[64:67], v[48:51]
    v_mfma_f32_16x16x32_bf16 v[48:51], a[36:39], a[68:71], v[48:51]
    ds_read_b64_tr_b16 a[24:25], v210 offset:0
    s_add_u32 s53, s53, 1
    v_mfma_f32_16x16x32_bf16 v[80:83], a[32:35], a[72:75], v[80:83]
    ds_read_b128 a[120:123], v205 offset:4096
    v_mfma_f32_16x16x32_bf16 v[80:83], a[36:39], a[76:79], v[80:83]
    ds_read_b64_tr_b16 a[26:27], v210 offset:2048
    v_mfma_f32_16x16x32_bf16 v[112:115], a[32:35], a[80:83], v[112:115]
    s_add_u32 m0, s59, 0
    v_mfma_f32_16x16x32_bf16 v[112:115], a[36:39], a[84:87], v[112:115]
    v_mfma_f32_16x16x32_bf16 v[144:147], a[32:35], a[88:91], v[144:147]
    ds_read_b64_tr_b16 a[28:29], v210 offset:16384
    v_mfma_f32_16x16x32_bf16 v[144:147], a[36:39], a[92:95], v[144:147]
    buffer_load_dwordx4 v197, s[12:15], s56 offen offset:0 lds
    v_mfma_f32_16x16x32_bf16 v[176:179], a[32:35], a[96:99], v[176:179]
    ds_read_b64_tr_b16 a[30:31], v210 offset:18432
    v_mfma_f32_16x16x32_bf16 v[176:179], a[36:39], a[100:103], v[176:179]
    ds_read_b128 a[124:127], v206 offset:4096
    v_mfma_f32_16x16x32_bf16 v[52:55], a[40:43], a[64:67], v[52:55]
    ds_read_b64_tr_b16 a[32:33], v211 offset:0
    v_mfma_f32_16x16x32_bf16 v[52:55], a[44:47], a[68:71], v[52:55]
    buffer_load_dwordx4 v198, s[12:15], s56 offen offset:1024 lds
    v_mfma_f32_16x16x32_bf16 v[84:87], a[40:43], a[72:75], v[84:87]
    ds_read_b128 a[128:131], v205 offset:6144
    v_mfma_f32_16x16x32_bf16 v[84:87], a[44:47], a[76:79], v[84:87]
    ds_read_b64_tr_b16 a[34:35], v211 offset:2048
    v_mfma_f32_16x16x32_bf16 v[116:119], a[40:43], a[80:83], v[116:119]
    buffer_load_dwordx4 v199, s[12:15], s56 offen offset:2048 lds
    v_mfma_f32_16x16x32_bf16 v[116:119], a[44:47], a[84:87], v[116:119]
    v_mfma_f32_16x16x32_bf16 v[148:151], a[40:43], a[88:91], v[148:151]
    ds_read_b64_tr_b16 a[36:37], v211 offset:16384
    v_mfma_f32_16x16x32_bf16 v[148:151], a[44:47], a[92:95], v[148:151]
    buffer_load_dwordx4 v200, s[12:15], s56 offen offset:3072 lds
    v_mfma_f32_16x16x32_bf16 v[180:183], a[40:43], a[96:99], v[180:183]
    ds_read_b64_tr_b16 a[38:39], v211 offset:18432
    v_mfma_f32_16x16x32_bf16 v[180:183], a[44:47], a[100:103], v[180:183]
    ds_read_b128 a[132:135], v206 offset:6144
    v_mfma_f32_16x16x32_bf16 v[56:59], a[48:51], a[64:67], v[56:59]
    v_mfma_f32_16x16x32_bf16 v[56:59], a[52:55], a[68:71], v[56:59]
    ds_read_b64_tr_b16 a[40:41], v212 offset:0
    s_add_u32 m0, s59, 4096
    v_mfma_f32_16x16x32_bf16 v[88:91], a[48:51], a[72:75], v[88:91]
    ds_read_b128 a[136:139], v205 offset:8192
    v_mfma_f32_16x16x32_bf16 v[88:91], a[52:55], a[76:79], v[88:91]
    ds_read_b64_tr_b16 a[42:43], v212 offset:2048
    v_mfma_f32_16x16x32_bf16 v[120:123], a[48:51], a[80:83], v[120:123]
    buffer_load_dwordx4 v201, s[12:15], s56 offen offset:0 lds
    v_mfma_f32_16x16x32_bf16 v[120:123], a[52:55], a[84:87], v[120:123]
    v_mfma_f32_16x16x32_bf16 v[152:155], a[48:51], a[88:91], v[152:155]
    ds_read_b64_tr_b16 a[44:45], v212 offset:16384
    v_mfma_f32_16x16x32_bf16 v[152:155], a[52:55], a[92:95], v[152:155]
    buffer_load_dwordx4 v202, s[12:15], s56 offen offset:1024 lds
    v_mfma_f32_16x16x32_bf16 v[184:187], a[48:51], a[96:99], v[184:187]
    ds_read_b64_tr_b16 a[46:47], v212 offset:18432
    s_add_u32 s82, s90, s58
    v_mfma_f32_16x16x32_bf16 v[184:187], a[52:55], a[100:103], v[184:187]
    ds_read_b128 a[140:143], v206 offset:8192
    v_mfma_f32_16x16x32_bf16 v[60:63], a[56:59], a[64:67], v[60:63]
    ds_read_b64_tr_b16 a[48:49], v213 offset:0
    s_add_u32 s100, s91, s57
    v_mfma_f32_16x16x32_bf16 v[60:63], a[60:63], a[68:71], v[60:63]
    buffer_load_dwordx4 v203, s[12:15], s56 offen offset:2048 lds
    v_mfma_f32_16x16x32_bf16 v[92:95], a[56:59], a[72:75], v[92:95]
    s_add_u32 s58, s58, 20480
    v_mfma_f32_16x16x32_bf16 v[92:95], a[60:63], a[76:79], v[92:95]
    ds_read_b64_tr_b16 a[50:51], v213 offset:2048
    v_mfma_f32_16x16x32_bf16 v[124:127], a[56:59], a[80:83], v[124:127]
    buffer_load_dwordx4 v204, s[12:15], s56 offen offset:3072 lds
    v_mfma_f32_16x16x32_bf16 v[124:127], a[60:63], a[84:87], v[124:127]
    s_cmp_gt_u32 s58, 139264
    s_cselect_b32 s58, 98304, s58
    v_mfma_f32_16x16x32_bf16 v[156:159], a[56:59], a[88:91], v[156:159]
    ds_read_b64_tr_b16 a[52:53], v213 offset:16384
    s_add_u32 s57, s57, 32768
    v_mfma_f32_16x16x32_bf16 v[156:159], a[60:63], a[92:95], v[156:159]
    s_add_u32 m0, s60, 0
    v_mfma_f32_16x16x32_bf16 v[188:191], a[56:59], a[96:99], v[188:191]
    ds_read_b64_tr_b16 a[54:55], v213 offset:18432
    v_mfma_f32_16x16x32_bf16 v[188:191], a[60:63], a[100:103], v[188:191]
    s_cmp_gt_u32 s57, 65536
    s_cselect_b32 s57, 0, s57
    s_waitcnt lgkmcnt(15)
    v_mfma_f32_16x16x32_bf16 v[32:35], a[0:3], a[104:107], v[32:35]
    buffer_load_dwordx4 v192, s[8:11], s55 offen offset:0 lds
    v_mfma_f32_16x16x32_bf16 v[32:35], a[4:7], a[108:111], v[32:35]
    ds_read_b64_tr_b16 a[56:57], v214 offset:0
    v_add_u32 v205, s58, v215
    v_mfma_f32_16x16x32_bf16 v[64:67], a[0:3], a[112:115], v[64:67]
    v_mfma_f32_16x16x32_bf16 v[64:67], a[4:7], a[116:119], v[64:67]
    ds_read_b64_tr_b16 a[58:59], v214 offset:2048
    v_add_u32 v206, s58, v216
    v_mfma_f32_16x16x32_bf16 v[96:99], a[0:3], a[120:123], v[96:99]
    buffer_load_dwordx4 v193, s[8:11], s55 offen offset:1024 lds
    v_mfma_f32_16x16x32_bf16 v[96:99], a[4:7], a[124:127], v[96:99]
    v_add_u32 v207, s57, v217
    s_waitcnt lgkmcnt(15)
    v_mfma_f32_16x16x32_bf16 v[128:131], a[0:3], a[128:131], v[128:131]
    ds_read_b64_tr_b16 a[60:61], v214 offset:16384
    v_add_u32 v208, s57, v218
    s_waitcnt lgkmcnt(13)
    v_mfma_f32_16x16x32_bf16 v[128:131], a[4:7], a[132:135], v[128:131]
    buffer_load_dwordx4 v194, s[8:11], s55 offen offset:2048 lds
    s_waitcnt lgkmcnt(11)
    v_mfma_f32_16x16x32_bf16 v[160:163], a[0:3], a[136:139], v[160:163]
    ds_read_b64_tr_b16 a[62:63], v214 offset:18432
    s_waitcnt lgkmcnt(8)
    v_mfma_f32_16x16x32_bf16 v[160:163], a[4:7], a[140:143], v[160:163]
    v_add_u32 v209, s57, v219
    v_mfma_f32_16x16x32_bf16 v[36:39], a[8:11], a[104:107], v[36:39]
    buffer_load_dwordx4 v195, s[8:11], s55 offen offset:3072 lds
    v_mfma_f32_16x16x32_bf16 v[36:39], a[12:15], a[108:111], v[36:39]
    v_add_u32 v210, s57, v220
    v_mfma_f32_16x16x32_bf16 v[68:71], a[8:11], a[112:115], v[68:71]
    v_mfma_f32_16x16x32_bf16 v[68:71], a[12:15], a[116:119], v[68:71]
    v_add_u32 v211, s57, v221
    v_mfma_f32_16x16x32_bf16 v[100:103], a[8:11], a[120:123], v[100:103]
    s_add_u32 m0, s60, 4096
    v_mfma_f32_16x16x32_bf16 v[100:103], a[12:15], a[124:127], v[100:103]
    v_add_u32 v212, s57, v222
    v_mfma_f32_16x16x32_bf16 v[132:135], a[8:11], a[128:131], v[132:135]
    v_mfma_f32_16x16x32_bf16 v[132:135], a[12:15], a[132:135], v[132:135]
    buffer_load_dwordx4 v196, s[8:11], s55 offen offset:0 lds
    v_mfma_f32_16x16x32_bf16 v[164:167], a[8:11], a[136:139], v[164:167]
    v_add_u32 v213, s57, v223
    v_add_u32 v214, s57, v224
    v_mfma_f32_16x16x32_bf16 v[164:167], a[12:15], a[140:143], v[164:167]
    s_mov_b32 s60, s82
    s_mov_b32 s59, s100
    s_bitcmp1_b32 s3, s53
    s_cbranch_scc0 Lg2
    buffer_load_dword v226, v225, s[28:31], s75 offen
    s_add_u32 s75, s75, 32768
Lg2:
    s_cmp_lt_u32 s53, 15
    s_cbranch_scc1 Lq_loop
    s_waitcnt vmcnt(13) lgkmcnt(0)
    s_barrier
    v_mfma_f32_16x16x32_bf16 v[40:43], a[16:19], a[104:107], v[40:43]
    ds_read_b64_tr_b16 a[0:1], v207 offset:0
    s_lshl4_add_u32 s96, s49, s50
    v_mfma_f32_16x16x32_bf16 v[40:43], a[20:23], a[108:111], v[40:43]
    ds_read_b64_tr_b16 a[2:3], v207 offset:2048
    s_add_u32 s61, s53, s54
    v_mfma_f32_16x16x32_bf16 v[72:75], a[16:19], a[112:115], v[72:75]
    ds_read_b128 a[64:67], v205 offset:0
    s_lshl_b32 s96, s96, 18
    v_mfma_f32_16x16x32_bf16 v[72:75], a[20:23], a[116:119], v[72:75]
    ds_read_b64_tr_b16 a[4:5], v207 offset:16384
    s_add_u32 s16, s66, s96
    s_addc_u32 s17, s67, 0
    v_mfma_f32_16x16x32_bf16 v[104:107], a[16:19], a[120:123], v[104:107]
    ds_read_b64_tr_b16 a[6:7], v207 offset:18432
    s_xor_b32 s61, s61, s53
    v_mfma_f32_16x16x32_bf16 v[104:107], a[20:23], a[124:127], v[104:107]
    ds_read_b64_tr_b16 a[8:9], v208 offset:0
    s_mov_b32 s18, 262144
    v_mfma_f32_16x16x32_bf16 v[136:139], a[16:19], a[128:131], v[136:139]
    ds_read_b64_tr_b16 a[10:11], v208 offset:2048
    s_mov_b32 s19, 0x20000
    v_mfma_f32_16x16x32_bf16 v[136:139], a[20:23], a[132:135], v[136:139]
    ds_read_b128 a[68:71], v206 offset:0
    v_mfma_f32_16x16x32_bf16 v[168:171], a[16:19], a[136:139], v[168:171]
    ds_read_b64_tr_b16 a[12:13], v208 offset:16384
    s_and_b32 s61, s61, 1
    v_mfma_f32_16x16x32_bf16 v[168:171], a[20:23], a[140:143], v[168:171]
    ds_read_b64_tr_b16 a[14:15], v208 offset:18432
    v_mfma_f32_16x16x32_bf16 v[44:47], a[24:27], a[104:107], v[44:47]
    s_add_u32 s20, s68, s96
    s_addc_u32 s21, s69, 0
    s_mov_b32 s22, 262144
    v_mfma_f32_16x16x32_bf16 v[44:47], a[28:31], a[108:111], v[44:47]
    ds_read_b64_tr_b16 a[16:17], v209 offset:0
    s_xor_b32 s61, s61, s53
    v_mfma_f32_16x16x32_bf16 v[76:79], a[24:27], a[112:115], v[76:79]
    ds_read_b128 a[72:75], v205 offset:2048
    s_mov_b32 s23, 0x20000
    v_mfma_f32_16x16x32_bf16 v[76:79], a[28:31], a[116:119], v[76:79]
    ds_read_b64_tr_b16 a[18:19], v209 offset:2048
    s_mul_i32 s96, s48, 10485760
    v_mfma_f32_16x16x32_bf16 v[108:111], a[24:27], a[120:123], v[108:111]
    s_lshl_b32 s55, s61, 7
    s_mul_i32 s97, s49, 1310720
    s_add_u32 s96, s96, s97
    v_mfma_f32_16x16x32_bf16 v[108:111], a[28:31], a[124:127], v[108:111]
    v_mfma_f32_16x16x32_bf16 v[140:143], a[24:27], a[128:131], v[140:143]
    ds_read_b64_tr_b16 a[20:21], v209 offset:16384
    s_lshl_b32 s97, s50, 13
    v_mfma_f32_16x16x32_bf16 v[140:143], a[28:31], a[132:135], v[140:143]
    ds_read_b128 a[76:79], v206 offset:2048
    s_add_u32 s96, s96, s97
    v_mfma_f32_16x16x32_bf16 v[172:175], a[24:27], a[136:139], v[172:175]
    ds_read_b64_tr_b16 a[22:23], v209 offset:18432
    s_lshl_b32 s56, s61, 19
    v_mfma_f32_16x16x32_bf16 v[172:175], a[28:31], a[140:143], v[172:175]
    s_sub_u32 s97, 1310720, s97
    v_mfma_f32_16x16x32_bf16 v[48:51], a[32:35], a[104:107], v[48:51]
    s_add_u32 s24, s88, s96
    s_addc_u32 s25, s89, 0
    v_mfma_f32_16x16x32_bf16 v[48:51], a[36:39], a[108:111], v[48:51]
    ds_read_b64_tr_b16 a[24:25], v210 offset:0
    s_add_u32 s53, s53, 1
    v_mfma_f32_16x16x32_bf16 v[80:83], a[32:35], a[112:115], v[80:83]
    ds_read_b128 a[80:83], v205 offset:4096
    s_mov_b32 s26, s97
    v_mfma_f32_16x16x32_bf16 v[80:83], a[36:39], a[116:119], v[80:83]
    ds_read_b64_tr_b16 a[26:27], v210 offset:2048
    s_mov_b32 s27, 0x20000
    v_mfma_f32_16x16x32_bf16 v[112:115], a[32:35], a[120:123], v[112:115]
    s_add_u32 m0, s59, 0
    s_mov_b32 s74, 0x3e0293ee
    v_mfma_f32_16x16x32_bf16 v[112:115], a[36:39], a[124:127], v[112:115]
    s_mov_b32 s94, 0
    v_mfma_f32_16x16x32_bf16 v[144:147], a[32:35], a[128:131], v[144:147]
    ds_read_b64_tr_b16 a[28:29], v210 offset:16384
    v_lshrrev_b32 v26, 4, v0
    v_mfma_f32_16x16x32_bf16 v[144:147], a[36:39], a[132:135], v[144:147]
    buffer_load_dwordx4 v197, s[12:15], s56 offen offset:0 lds
    v_mfma_f32_16x16x32_bf16 v[176:179], a[32:35], a[136:139], v[176:179]
    ds_read_b64_tr_b16 a[30:31], v210 offset:18432
    s_lshl_b32 s96, s5, 12
    v_mfma_f32_16x16x32_bf16 v[176:179], a[36:39], a[140:143], v[176:179]
    ds_read_b128 a[84:87], v206 offset:4096
    v_mfma_f32_16x16x32_bf16 v[52:55], a[40:43], a[104:107], v[52:55]
    ds_read_b64_tr_b16 a[32:33], v211 offset:0
    s_lshl_b32 s97, s6, 17
    v_mfma_f32_16x16x32_bf16 v[52:55], a[44:47], a[108:111], v[52:55]
    buffer_load_dwordx4 v198, s[12:15], s56 offen offset:1024 lds
    v_mfma_f32_16x16x32_bf16 v[84:87], a[40:43], a[112:115], v[84:87]
    ds_read_b128 a[88:91], v205 offset:6144
    s_add_u32 s96, s96, s97
    v_mfma_f32_16x16x32_bf16 v[84:87], a[44:47], a[116:119], v[84:87]
    ds_read_b64_tr_b16 a[34:35], v211 offset:2048
    v_lshl_add_u32 v27, v26, 8, s96
    v_mfma_f32_16x16x32_bf16 v[116:119], a[40:43], a[120:123], v[116:119]
    buffer_load_dwordx4 v199, s[12:15], s56 offen offset:2048 lds
    v_mfma_f32_16x16x32_bf16 v[116:119], a[44:47], a[124:127], v[116:119]
    v_and_b32 v28, 15, v0
    v_xor_b32 v29, v28, v26
    v_mfma_f32_16x16x32_bf16 v[148:151], a[40:43], a[128:131], v[148:151]
    ds_read_b64_tr_b16 a[36:37], v211 offset:16384
    v_lshl_add_u32 v1, v29, 4, v27
    v_mfma_f32_16x16x32_bf16 v[148:151], a[44:47], a[132:135], v[148:151]
    buffer_load_dwordx4 v200, s[12:15], s56 offen offset:3072 lds
    v_mfma_f32_16x16x32_bf16 v[180:183], a[40:43], a[136:139], v[180:183]
    ds_read_b64_tr_b16 a[38:39], v211 offset:18432
    v_xor_b32 v2, 64, v1
    v_mfma_f32_16x16x32_bf16 v[180:183], a[44:47], a[140:143], v[180:183]
    ds_read_b128 a[92:95], v206 offset:6144
    v_xor_b32 v3, 128, v1
    v_mfma_f32_16x16x32_bf16 v[56:59], a[48:51], a[104:107], v[56:59]
    v_xor_b32 v4, 192, v1
    v_mfma_f32_16x16x32_bf16 v[56:59], a[52:55], a[108:111], v[56:59]
    ds_read_b64_tr_b16 a[40:41], v212 offset:0
    s_add_u32 m0, s59, 4096
    v_mfma_f32_16x16x32_bf16 v[88:91], a[48:51], a[112:115], v[88:91]
    ds_read_b128 a[96:99], v205 offset:8192
    v_lshlrev_b32 v30, 1, v26
    v_mfma_f32_16x16x32_bf16 v[88:91], a[52:55], a[116:119], v[88:91]
    ds_read_b64_tr_b16 a[42:43], v212 offset:2048
    v_xor_b32 v30, v30, v28
    v_mfma_f32_16x16x32_bf16 v[120:123], a[48:51], a[120:123], v[120:123]
    buffer_load_dwordx4 v201, s[12:15], s56 offen offset:0 lds
    v_mfma_f32_16x16x32_bf16 v[120:123], a[52:55], a[124:127], v[120:123]
    v_lshl_add_u32 v5, v30, 4, v27
    v_mfma_f32_16x16x32_bf16 v[152:155], a[48:51], a[128:131], v[152:155]
    ds_read_b64_tr_b16 a[44:45], v212 offset:16384
    v_xor_b32 v6, 128, v5
    v_mfma_f32_16x16x32_bf16 v[152:155], a[52:55], a[132:135], v[152:155]
    buffer_load_dwordx4 v202, s[12:15], s56 offen offset:1024 lds
    v_mfma_f32_16x16x32_bf16 v[184:187], a[48:51], a[136:139], v[184:187]
    ds_read_b64_tr_b16 a[46:47], v212 offset:18432
    s_lshl_b32 s95, s4, 12
    s_add_u32 s82, s90, s58
    v_mfma_f32_16x16x32_bf16 v[184:187], a[52:55], a[140:143], v[184:187]
    ds_read_b128 a[100:103], v206 offset:8192
    s_mul_i32 s64, s6, 8192
    v_mfma_f32_16x16x32_bf16 v[60:63], a[56:59], a[104:107], v[60:63]
    ds_read_b64_tr_b16 a[48:49], v213 offset:0
    s_lshl_b32 s96, s6, 13
    v_mfma_f32_16x16x32_bf16 v[60:63], a[60:63], a[108:111], v[60:63]
    buffer_load_dwordx4 v203, s[12:15], s56 offen offset:2048 lds
    v_mfma_f32_16x16x32_bf16 v[92:95], a[56:59], a[112:115], v[92:95]
    s_add_u32 s96, s96, 65536
    s_add_u32 s100, s91, s57
    s_add_u32 s58, s58, 20480
    v_mfma_f32_16x16x32_bf16 v[92:95], a[60:63], a[116:119], v[92:95]
    ds_read_b64_tr_b16 a[50:51], v213 offset:2048
    v_lshl_add_u32 v27, v28, 8, s96
    v_mfma_f32_16x16x32_bf16 v[124:127], a[56:59], a[120:123], v[124:127]
    buffer_load_dwordx4 v204, s[12:15], s56 offen offset:3072 lds
    v_mfma_f32_16x16x32_bf16 v[124:127], a[60:63], a[124:127], v[124:127]
    v_lshl_add_u32 v7, v29, 4, v27
    v_mfma_f32_16x16x32_bf16 v[156:159], a[56:59], a[128:131], v[156:159]
    ds_read_b64_tr_b16 a[52:53], v213 offset:16384
    v_xor_b32 v8, 64, v7
    v_mfma_f32_16x16x32_bf16 v[156:159], a[60:63], a[132:135], v[156:159]
    s_add_u32 m0, s60, 0
    s_cmp_gt_u32 s58, 139264
    s_cselect_b32 s58, 98304, s58
    v_mfma_f32_16x16x32_bf16 v[188:191], a[56:59], a[136:139], v[188:191]
    ds_read_b64_tr_b16 a[54:55], v213 offset:18432
    v_xor_b32 v9, 128, v7
    v_mfma_f32_16x16x32_bf16 v[188:191], a[60:63], a[140:143], v[188:191]
    v_xor_b32 v10, 192, v7
    s_add_u32 s57, s57, 32768
    s_cmp_gt_u32 s57, 65536
    s_cselect_b32 s57, 0, s57
    s_waitcnt lgkmcnt(15)
    v_mfma_f32_16x16x32_bf16 v[32:35], a[0:3], a[64:67], v[32:35]
    buffer_load_dwordx4 v192, s[8:11], s55 offen offset:0 lds
    v_mfma_f32_16x16x32_bf16 v[32:35], a[4:7], a[68:71], v[32:35]
    ds_read_b64_tr_b16 a[56:57], v214 offset:0
    v_lshrrev_b32 v27, 2, v0
    v_mfma_f32_16x16x32_bf16 v[64:67], a[0:3], a[72:75], v[64:67]
    v_and_b32 v29, 7, v27
    v_add_u32 v205, s58, v215
    v_mfma_f32_16x16x32_bf16 v[64:67], a[4:7], a[76:79], v[64:67]
    ds_read_b64_tr_b16 a[58:59], v214 offset:2048
    s_add_u32 s96, s96, 16384
    v_mfma_f32_16x16x32_bf16 v[96:99], a[0:3], a[80:83], v[96:99]
    buffer_load_dwordx4 v193, s[8:11], s55 offen offset:1024 lds
    v_mfma_f32_16x16x32_bf16 v[96:99], a[4:7], a[84:87], v[96:99]
    v_lshl_add_u32 v27, v27, 8, s96
    v_add_u32 v206, s58, v216
    v_add_u32 v207, s57, v217
    s_waitcnt lgkmcnt(15)
    v_mfma_f32_16x16x32_bf16 v[128:131], a[0:3], a[88:91], v[128:131]
    ds_read_b64_tr_b16 a[60:61], v214 offset:16384
    v_and_b32 v30, 3, v0
    s_waitcnt lgkmcnt(13)
    v_mfma_f32_16x16x32_bf16 v[128:131], a[4:7], a[92:95], v[128:131]
    buffer_load_dwordx4 v194, s[8:11], s55 offen offset:2048 lds
    s_waitcnt lgkmcnt(11)
    v_mfma_f32_16x16x32_bf16 v[160:163], a[0:3], a[96:99], v[160:163]
    ds_read_b64_tr_b16 a[62:63], v214 offset:18432
    v_lshl_add_u32 v27, v30, 3, v27
    s_waitcnt lgkmcnt(8)
    v_mfma_f32_16x16x32_bf16 v[160:163], a[4:7], a[100:103], v[160:163]
    v_lshl_add_u32 v11, v29, 5, v27
    v_add_u32 v208, s57, v218
    v_mfma_f32_16x16x32_bf16 v[36:39], a[8:11], a[64:67], v[36:39]
    buffer_load_dwordx4 v195, s[8:11], s55 offen offset:3072 lds
    v_mfma_f32_16x16x32_bf16 v[36:39], a[12:15], a[68:71], v[36:39]
    v_xor_b32 v12, 32, v11
    v_add_u32 v209, s57, v219
    v_mfma_f32_16x16x32_bf16 v[68:71], a[8:11], a[72:75], v[68:71]
    v_xor_b32 v13, 64, v11
    v_add_u32 v210, s57, v220
    v_mfma_f32_16x16x32_bf16 v[68:71], a[12:15], a[76:79], v[68:71]
    v_xor_b32 v14, 96, v11
    v_add_u32 v211, s57, v221
    v_mfma_f32_16x16x32_bf16 v[100:103], a[8:11], a[80:83], v[100:103]
    s_add_u32 m0, s60, 4096
    v_mfma_f32_16x16x32_bf16 v[100:103], a[12:15], a[84:87], v[100:103]
    v_xor_b32 v15, 128, v11
    v_add_u32 v212, s57, v222
    v_mfma_f32_16x16x32_bf16 v[132:135], a[8:11], a[88:91], v[132:135]
    v_xor_b32 v16, 160, v11
    v_mfma_f32_16x16x32_bf16 v[132:135], a[12:15], a[92:95], v[132:135]
    buffer_load_dwordx4 v196, s[8:11], s55 offen offset:0 lds
    v_mfma_f32_16x16x32_bf16 v[164:167], a[8:11], a[96:99], v[164:167]
    v_xor_b32 v17, 192, v11
    v_add_u32 v213, s57, v223
    v_mfma_f32_16x16x32_bf16 v[164:167], a[12:15], a[100:103], v[164:167]
    v_xor_b32 v18, 224, v11
    v_add_u32 v214, s57, v224
    s_waitcnt vmcnt(13) lgkmcnt(0)
    s_barrier
    v_mfma_f32_16x16x32_bf16 v[40:43], a[16:19], a[64:67], v[40:43]
    ds_read_b64_tr_b16 a[0:1], v207 offset:0
    s_lshl_b32 s96, s4, 12
    v_mfma_f32_16x16x32_bf16 v[40:43], a[20:23], a[68:71], v[40:43]
    ds_read_b64_tr_b16 a[2:3], v207 offset:2048
    s_add_u32 s96, s96, 131072
    v_mfma_f32_16x16x32_bf16 v[72:75], a[16:19], a[72:75], v[72:75]
    ds_read_b128 a[104:107], v205 offset:0
    v_lshl_add_u32 v253, v0, 4, s96
    v_mfma_f32_16x16x32_bf16 v[72:75], a[20:23], a[76:79], v[72:75]
    ds_read_b64_tr_b16 a[4:5], v207 offset:16384
    s_xor_b32 s92, s64, 0
    v_mfma_f32_16x16x32_bf16 v[104:107], a[16:19], a[80:83], v[104:107]
    ds_read_b64_tr_b16 a[6:7], v207 offset:18432
    v_lshrrev_b32 v27, 5, v0
    v_mfma_f32_16x16x32_bf16 v[104:107], a[20:23], a[84:87], v[104:107]
    ds_read_b64_tr_b16 a[8:9], v208 offset:0
    v_lshl_add_u32 v27, v27, 4, v28
    v_mfma_f32_16x16x32_bf16 v[136:139], a[16:19], a[88:91], v[136:139]
    ds_read_b64_tr_b16 a[10:11], v208 offset:2048
    v_lshl_add_u32 v27, v27, 4, s96
    v_mfma_f32_16x16x32_bf16 v[136:139], a[20:23], a[92:95], v[136:139]
    ds_read_b128 a[108:111], v206 offset:0
    v_and_b32 v26, 1, v26
    v_mfma_f32_16x16x32_bf16 v[168:171], a[16:19], a[96:99], v[168:171]
    ds_read_b64_tr_b16 a[12:13], v208 offset:16384
    v_lshl_add_u32 v252, v26, 3, v27
    v_mfma_f32_16x16x32_bf16 v[168:171], a[20:23], a[100:103], v[168:171]
    ds_read_b64_tr_b16 a[14:15], v208 offset:18432
    s_lshl_b32 s96, s6, 12
    v_mfma_f32_16x16x32_bf16 v[44:47], a[24:27], a[64:67], v[44:47]
    s_add_u32 m0, s95, 65536
    s_mul_i32 s97, s5, 655360
    v_mfma_f32_16x16x32_bf16 v[44:47], a[28:31], a[68:71], v[44:47]
    ds_read_b64_tr_b16 a[16:17], v209 offset:0
    s_add_u32 s96, s96, s97
    v_mfma_f32_16x16x32_bf16 v[76:79], a[24:27], a[72:75], v[76:79]
    ds_read_b128 a[112:115], v205 offset:2048
    v_lshl_add_u32 v24, v0, 4, s96
    v_mfma_f32_16x16x32_bf16 v[76:79], a[28:31], a[76:79], v[76:79]
    ds_read_b64_tr_b16 a[18:19], v209 offset:2048
    s_mul_i32 s96, s6, 40960
    v_mfma_f32_16x16x32_bf16 v[108:111], a[24:27], a[80:83], v[108:111]
    s_mul_i32 s97, s5, 10240
    v_mfma_f32_16x16x32_bf16 v[108:111], a[28:31], a[84:87], v[108:111]
    s_add_u32 s96, s96, s97
    v_mfma_f32_16x16x32_bf16 v[140:143], a[24:27], a[88:91], v[140:143]
    ds_read_b64_tr_b16 a[20:21], v209 offset:16384
    s_add_u32 s96, s96, 65536
    v_mfma_f32_16x16x32_bf16 v[140:143], a[28:31], a[92:95], v[140:143]
    buffer_load_dwordx4 v1, s[16:19], s92 offen offset:0 nt lds
    v_mfma_f32_16x16x32_bf16 v[172:175], a[24:27], a[96:99], v[172:175]
    ds_read_b64_tr_b16 a[22:23], v209 offset:18432
    v_lshl_add_u32 v25, v0, 4, s96
    v_mfma_f32_16x16x32_bf16 v[172:175], a[28:31], a[100:103], v[172:175]
    ds_read_b128 a[116:119], v206 offset:2048
    v_mov_b32 v26, 0x3f803f80
    v_mfma_f32_16x16x32_bf16 v[48:51], a[32:35], a[64:67], v[48:51]
    v_mov_b32 v19, 0xff800000
    v_mov_b32 v20, 0xff800000
    v_mfma_f32_16x16x32_bf16 v[48:51], a[36:39], a[68:71], v[48:51]
    ds_read_b64_tr_b16 a[24:25], v210 offset:0
    v_mov_b32 v21, 0xff800000
    v_mfma_f32_16x16x32_bf16 v[80:83], a[32:35], a[72:75], v[80:83]
    ds_read_b128 a[120:123], v205 offset:4096
    v_mov_b32 v22, 0xff800000
    v_mfma_f32_16x16x32_bf16 v[80:83], a[36:39], a[76:79], v[80:83]
    ds_read_b64_tr_b16 a[26:27], v210 offset:2048
    v_mov_b32 v23, 0xff800000
    v_mfma_f32_16x16x32_bf16 v[112:115], a[32:35], a[80:83], v[112:115]
    v_accvgpr_write_b32 a248, v26
    v_mfma_f32_16x16x32_bf16 v[112:115], a[36:39], a[84:87], v[112:115]
    buffer_load_dwordx4 v2, s[16:19], s92 offen offset:1024 nt lds
    v_mfma_f32_16x16x32_bf16 v[144:147], a[32:35], a[88:91], v[144:147]
    ds_read_b64_tr_b16 a[28:29], v210 offset:16384
    v_accvgpr_write_b32 a249, v26
    v_mfma_f32_16x16x32_bf16 v[144:147], a[36:39], a[92:95], v[144:147]
    ds_read_b128 a[124:127], v206 offset:4096
    v_accvgpr_write_b32 a250, v26
    v_mfma_f32_16x16x32_bf16 v[176:179], a[32:35], a[96:99], v[176:179]
    ds_read_b64_tr_b16 a[30:31], v210 offset:18432
    v_accvgpr_write_b32 a251, v26
    v_mfma_f32_16x16x32_bf16 v[176:179], a[36:39], a[100:103], v[176:179]
    s_lshl_b32 s96, s51, 22
    v_mfma_f32_16x16x32_bf16 v[52:55], a[40:43], a[64:67], v[52:55]
    s_lshl_b32 s97, s52, 8
    v_mfma_f32_16x16x32_bf16 v[52:55], a[44:47], a[68:71], v[52:55]
    ds_read_b64_tr_b16 a[32:33], v211 offset:0
    s_add_u32 s96, s96, s97
    v_mfma_f32_16x16x32_bf16 v[84:87], a[40:43], a[72:75], v[84:87]
    buffer_load_dwordx4 v3, s[16:19], s92 offen offset:2048 nt lds
    v_mfma_f32_16x16x32_bf16 v[84:87], a[44:47], a[76:79], v[84:87]
    ds_read_b64_tr_b16 a[34:35], v211 offset:2048
    s_sub_u32 s97, 4194304, s97
    v_mfma_f32_16x16x32_bf16 v[116:119], a[40:43], a[80:83], v[116:119]
    ds_read_b128 a[128:131], v205 offset:6144
    v_mfma_f32_16x16x32_bf16 v[116:119], a[44:47], a[84:87], v[116:119]
    s_add_u32 s28, s72, s96
    s_addc_u32 s29, s73, 0
    s_mov_b32 s30, s97
    v_mfma_f32_16x16x32_bf16 v[148:151], a[40:43], a[88:91], v[148:151]
    ds_read_b64_tr_b16 a[36:37], v211 offset:16384
    s_mov_b32 s31, 0x20000
    v_mfma_f32_16x16x32_bf16 v[148:151], a[44:47], a[92:95], v[148:151]
    ds_read_b128 a[132:135], v206 offset:6144
    s_mov_b32 s98, 33554432
    v_mfma_f32_16x16x32_bf16 v[180:183], a[40:43], a[96:99], v[180:183]
    ds_read_b64_tr_b16 a[38:39], v211 offset:18432
    v_mfma_f32_16x16x32_bf16 v[180:183], a[44:47], a[100:103], v[180:183]
    buffer_load_dwordx4 v4, s[16:19], s92 offen offset:3072 nt lds
    v_mfma_f32_16x16x32_bf16 v[56:59], a[48:51], a[64:67], v[56:59]
    s_add_u32 s76, s88, s98
    s_addc_u32 s77, s89, 0
    s_mov_b32 s78, 10485760
    v_mfma_f32_16x16x32_bf16 v[56:59], a[52:55], a[68:71], v[56:59]
    ds_read_b64_tr_b16 a[40:41], v212 offset:0
    s_mov_b32 s79, 0x20000
    v_mfma_f32_16x16x32_bf16 v[88:91], a[48:51], a[72:75], v[88:91]
    ds_read_b128 a[136:139], v205 offset:8192
    s_mul_i32 s96, s48, 10485760
    v_mfma_f32_16x16x32_bf16 v[88:91], a[52:55], a[76:79], v[88:91]
    ds_read_b64_tr_b16 a[42:43], v212 offset:2048
    s_mul_i32 s97, s49, 1310720
    v_mfma_f32_16x16x32_bf16 v[120:123], a[48:51], a[80:83], v[120:123]
    s_add_u32 s96, s96, s97
    s_lshl_b32 s97, s51, 16
    v_mfma_f32_16x16x32_bf16 v[120:123], a[52:55], a[84:87], v[120:123]
    s_add_u32 s96, s96, s97
    s_sub_u32 s97, 1310720, s97
    v_mfma_f32_16x16x32_bf16 v[152:155], a[48:51], a[88:91], v[152:155]
    ds_read_b64_tr_b16 a[44:45], v212 offset:16384
    s_add_u32 m0, s95, 81920
    v_mfma_f32_16x16x32_bf16 v[152:155], a[52:55], a[92:95], v[152:155]
    ds_read_b128 a[140:143], v206 offset:8192
    v_mfma_f32_16x16x32_bf16 v[184:187], a[48:51], a[96:99], v[184:187]
    ds_read_b64_tr_b16 a[46:47], v212 offset:18432
    s_add_u32 s82, s90, s58
    v_mfma_f32_16x16x32_bf16 v[184:187], a[52:55], a[100:103], v[184:187]
    s_add_u32 s40, s88, s96
    s_addc_u32 s41, s89, 0
    s_mov_b32 s42, s97
    v_mfma_f32_16x16x32_bf16 v[60:63], a[56:59], a[64:67], v[60:63]
    s_mov_b32 s43, 0x20000
    s_mul_i32 s96, s49, 655360
    s_add_u32 s100, s91, s57
    v_mfma_f32_16x16x32_bf16 v[60:63], a[60:63], a[68:71], v[60:63]
    ds_read_b64_tr_b16 a[48:49], v213 offset:0
    s_lshl_b32 s97, s48, 11
    v_mfma_f32_16x16x32_bf16 v[92:95], a[56:59], a[72:75], v[92:95]
    s_lshl_b32 s98, s52, 8
    s_add_u32 s58, s58, 20480
    v_mfma_f32_16x16x32_bf16 v[92:95], a[60:63], a[76:79], v[92:95]
    buffer_load_dwordx4 v5, s[20:23], s92 offen offset:0 nt lds
    v_mfma_f32_16x16x32_bf16 v[124:127], a[56:59], a[80:83], v[124:127]
    ds_read_b64_tr_b16 a[50:51], v213 offset:2048
    s_add_u32 s97, s97, s98
    v_mfma_f32_16x16x32_bf16 v[124:127], a[60:63], a[84:87], v[124:127]
    s_add_u32 s96, s96, s97
    s_sub_u32 s97, 655360, s97
    s_cmp_gt_u32 s58, 139264
    s_cselect_b32 s58, 98304, s58
    v_mfma_f32_16x16x32_bf16 v[156:159], a[56:59], a[88:91], v[156:159]
    ds_read_b64_tr_b16 a[52:53], v213 offset:16384
    s_add_u32 s57, s57, 32768
    v_mfma_f32_16x16x32_bf16 v[156:159], a[60:63], a[92:95], v[156:159]
    s_add_u32 s32, s84, s96
    s_addc_u32 s33, s85, 0
    v_mfma_f32_16x16x32_bf16 v[188:191], a[56:59], a[96:99], v[188:191]
    ds_read_b64_tr_b16 a[54:55], v213 offset:18432
    s_mov_b32 s34, s97
    v_mfma_f32_16x16x32_bf16 v[188:191], a[60:63], a[100:103], v[188:191]
    s_mov_b32 s35, 0x20000
    s_cmp_gt_u32 s57, 65536
    s_cselect_b32 s57, 0, s57
    s_waitcnt lgkmcnt(15)
    v_mfma_f32_16x16x32_bf16 v[32:35], a[0:3], a[104:107], v[32:35]
    ds_read_b64_tr_b16 a[56:57], v214 offset:0
    s_mov_b32 s97, 50331648
    v_mfma_f32_16x16x32_bf16 v[32:35], a[4:7], a[108:111], v[32:35]
    buffer_load_dwordx4 v6, s[20:23], s92 offen offset:1024 nt lds
    v_add_u32 v205, s58, v215
    v_mfma_f32_16x16x32_bf16 v[64:67], a[0:3], a[112:115], v[64:67]
    s_add_u32 s44, s88, s97
    s_addc_u32 s45, s89, 0
    s_mov_b32 s46, 32768
    v_mfma_f32_16x16x32_bf16 v[64:67], a[4:7], a[116:119], v[64:67]
    ds_read_b64_tr_b16 a[58:59], v214 offset:2048
    s_mov_b32 s47, 0x20000
    v_mfma_f32_16x16x32_bf16 v[96:99], a[0:3], a[120:123], v[96:99]
    s_mov_b32 s36, s86
    v_add_u32 v206, s58, v216
    v_mfma_f32_16x16x32_bf16 v[96:99], a[4:7], a[124:127], v[96:99]
    s_mov_b32 s37, s87
    v_add_u32 v207, s57, v217
    s_waitcnt lgkmcnt(15)
    v_mfma_f32_16x16x32_bf16 v[128:131], a[0:3], a[128:131], v[128:131]
    ds_read_b64_tr_b16 a[60:61], v214 offset:16384
    s_mov_b32 s38, 256
    s_waitcnt lgkmcnt(14)
    v_mfma_f32_16x16x32_bf16 v[128:131], a[4:7], a[132:135], v[128:131]
    s_mov_b32 s39, 0x20000
    v_add_u32 v208, s57, v218
    s_waitcnt lgkmcnt(11)
    v_mfma_f32_16x16x32_bf16 v[160:163], a[0:3], a[136:139], v[160:163]
    buffer_load_dwordx4 v5, s[20:23], s92 offen offset:2048 nt lds
    s_waitcnt lgkmcnt(8)
    v_mfma_f32_16x16x32_bf16 v[160:163], a[4:7], a[140:143], v[160:163]
    ds_read_b64_tr_b16 a[62:63], v214 offset:18432
    s_lshl_b32 s96, s51, 3
    v_mfma_f32_16x16x32_bf16 v[36:39], a[8:11], a[104:107], v[36:39]
    s_lshl_b32 s101, 0xff, s96
    s_bitset0_b32 s101, s50
    v_mfma_f32_16x16x32_bf16 v[36:39], a[12:15], a[108:111], v[36:39]
    s_lshl_b32 s93, s52, 2
    v_add_u32 v209, s57, v219
    v_mfma_f32_16x16x32_bf16 v[68:71], a[8:11], a[112:115], v[68:71]
    v_add_u32 v210, s57, v220
    v_mfma_f32_16x16x32_bf16 v[68:71], a[12:15], a[116:119], v[68:71]
    s_lshl_b32 s96, s2, 7
    v_add_u32 v211, s57, v221
    v_mfma_f32_16x16x32_bf16 v[100:103], a[8:11], a[120:123], v[100:103]
    v_lshl_add_u32 v26, v0, 2, s96
    v_and_b32 v27, 32, v0
    v_mfma_f32_16x16x32_bf16 v[100:103], a[12:15], a[124:127], v[100:103]
    buffer_load_dwordx4 v6, s[20:23], s92 offen offset:3072 nt lds
    v_mfma_f32_16x16x32_bf16 v[132:135], a[8:11], a[128:131], v[132:135]
    v_lshl_add_u32 v26, v27, 24, v26
    v_add_u32 v212, s57, v222
    v_mfma_f32_16x16x32_bf16 v[132:135], a[12:15], a[132:135], v[132:135]
    s_cmp_eq_u32 s4, 0
    s_cselect_b32 s83, 0, 0x40000000
    v_mfma_f32_16x16x32_bf16 v[164:167], a[8:11], a[136:139], v[164:167]
    v_mov_b32 v28, 0
    v_add_u32 v213, s57, v223
    v_add_u32 v214, s57, v224
    v_mfma_f32_16x16x32_bf16 v[164:167], a[12:15], a[140:143], v[164:167]
    buffer_store_dword v28, v26, s[44:47], s83 offen sc1
    s_waitcnt vmcnt(8) lgkmcnt(0)
    s_barrier
    v_mfma_f32_16x16x32_bf16 v[40:43], a[16:19], a[104:107], v[40:43]
    ds_read_b64_tr_b16 a[0:1], v207 offset:0
    v_mfma_f32_16x16x32_bf16 v[40:43], a[20:23], a[108:111], v[40:43]
    ds_read_b64_tr_b16 a[2:3], v207 offset:2048
    s_xor_b32 s92, s64, 8192
    v_mfma_f32_16x16x32_bf16 v[72:75], a[16:19], a[112:115], v[72:75]
    ds_read_b128 a[64:67], v205 offset:0
    v_mfma_f32_16x16x32_bf16 v[72:75], a[20:23], a[116:119], v[72:75]
    ds_read_b64_tr_b16 a[4:5], v207 offset:16384
    v_mfma_f32_16x16x32_bf16 v[104:107], a[16:19], a[120:123], v[104:107]
    ds_read_b64_tr_b16 a[6:7], v207 offset:18432
    v_mfma_f32_16x16x32_bf16 v[104:107], a[20:23], a[124:127], v[104:107]
    ds_read_b64_tr_b16 a[8:9], v208 offset:0
    s_add_u32 m0, s95, 98304
    v_mfma_f32_16x16x32_bf16 v[136:139], a[16:19], a[128:131], v[136:139]
    ds_read_b64_tr_b16 a[10:11], v208 offset:2048
    v_mfma_f32_16x16x32_bf16 v[136:139], a[20:23], a[132:135], v[136:139]
    ds_read_b64_tr_b16 a[12:13], v208 offset:16384
    v_mfma_f32_16x16x32_bf16 v[168:171], a[16:19], a[136:139], v[168:171]
    buffer_load_dwordx4 v1, s[16:19], s92 offen offset:0 nt lds
    v_mfma_f32_16x16x32_bf16 v[168:171], a[20:23], a[140:143], v[168:171]
    ds_read_b64_tr_b16 a[14:15], v208 offset:18432
    v_mfma_f32_16x16x32_bf16 v[44:47], a[24:27], a[104:107], v[44:47]
    ds_read_b128 a[68:71], v206 offset:0
    v_mfma_f32_16x16x32_bf16 v[44:47], a[28:31], a[108:111], v[44:47]
    ds_read_b64_tr_b16 a[16:17], v209 offset:0
    v_mfma_f32_16x16x32_bf16 v[76:79], a[24:27], a[112:115], v[76:79]
    buffer_load_dwordx4 v2, s[16:19], s92 offen offset:1024 nt lds
    v_mfma_f32_16x16x32_bf16 v[76:79], a[28:31], a[116:119], v[76:79]
    ds_read_b64_tr_b16 a[18:19], v209 offset:2048
    v_mfma_f32_16x16x32_bf16 v[108:111], a[24:27], a[120:123], v[108:111]
    ds_read_b128 a[72:75], v205 offset:2048
    v_mfma_f32_16x16x32_bf16 v[108:111], a[28:31], a[124:127], v[108:111]
    ds_read_b64_tr_b16 a[20:21], v209 offset:16384
    v_mfma_f32_16x16x32_bf16 v[140:143], a[24:27], a[128:131], v[140:143]
    buffer_load_dwordx4 v3, s[16:19], s92 offen offset:2048 nt lds
    v_mfma_f32_16x16x32_bf16 v[140:143], a[28:31], a[132:135], v[140:143]
    ds_read_b128 a[76:79], v206 offset:2048
    v_mfma_f32_16x16x32_bf16 v[172:175], a[24:27], a[136:139], v[172:175]
    ds_read_b64_tr_b16 a[22:23], v209 offset:18432
    v_mfma_f32_16x16x32_bf16 v[172:175], a[28:31], a[140:143], v[172:175]
    buffer_load_dwordx4 v4, s[16:19], s92 offen offset:3072 nt lds
    v_mfma_f32_16x16x32_bf16 v[48:51], a[32:35], a[104:107], v[48:51]
    v_mfma_f32_16x16x32_bf16 v[48:51], a[36:39], a[108:111], v[48:51]
    ds_read_b64_tr_b16 a[24:25], v210 offset:0
    v_mfma_f32_16x16x32_bf16 v[80:83], a[32:35], a[112:115], v[80:83]
    ds_read_b128 a[80:83], v205 offset:4096
    v_mfma_f32_16x16x32_bf16 v[80:83], a[36:39], a[116:119], v[80:83]
    ds_read_b64_tr_b16 a[26:27], v210 offset:2048
    s_add_u32 m0, s95, 114688
    v_mfma_f32_16x16x32_bf16 v[112:115], a[32:35], a[120:123], v[112:115]
    v_mfma_f32_16x16x32_bf16 v[112:115], a[36:39], a[124:127], v[112:115]
    ds_read_b64_tr_b16 a[28:29], v210 offset:16384
    v_mfma_f32_16x16x32_bf16 v[144:147], a[32:35], a[128:131], v[144:147]
    buffer_load_dwordx4 v5, s[20:23], s92 offen offset:0 nt lds
    v_mfma_f32_16x16x32_bf16 v[144:147], a[36:39], a[132:135], v[144:147]
    ds_read_b128 a[84:87], v206 offset:4096
    v_mfma_f32_16x16x32_bf16 v[176:179], a[32:35], a[136:139], v[176:179]
    ds_read_b64_tr_b16 a[30:31], v210 offset:18432
    v_mfma_f32_16x16x32_bf16 v[176:179], a[36:39], a[140:143], v[176:179]
    v_mfma_f32_16x16x32_bf16 v[52:55], a[40:43], a[104:107], v[52:55]
    buffer_load_dwordx4 v6, s[20:23], s92 offen offset:1024 nt lds
    v_mfma_f32_16x16x32_bf16 v[52:55], a[44:47], a[108:111], v[52:55]
    ds_read_b64_tr_b16 a[32:33], v211 offset:0
    v_mfma_f32_16x16x32_bf16 v[84:87], a[40:43], a[112:115], v[84:87]
    ds_read_b128 a[88:91], v205 offset:6144
    v_mfma_f32_16x16x32_bf16 v[84:87], a[44:47], a[116:119], v[84:87]
    ds_read_b64_tr_b16 a[34:35], v211 offset:2048
    v_mfma_f32_16x16x32_bf16 v[116:119], a[40:43], a[120:123], v[116:119]
    buffer_load_dwordx4 v5, s[20:23], s92 offen offset:2048 nt lds
    v_mfma_f32_16x16x32_bf16 v[116:119], a[44:47], a[124:127], v[116:119]
    v_mfma_f32_16x16x32_bf16 v[148:151], a[40:43], a[128:131], v[148:151]
    ds_read_b64_tr_b16 a[36:37], v211 offset:16384
    v_mfma_f32_16x16x32_bf16 v[148:151], a[44:47], a[132:135], v[148:151]
    buffer_load_dwordx4 v6, s[20:23], s92 offen offset:3072 nt lds
    v_mfma_f32_16x16x32_bf16 v[180:183], a[40:43], a[136:139], v[180:183]
    ds_read_b64_tr_b16 a[38:39], v211 offset:18432
    v_mfma_f32_16x16x32_bf16 v[180:183], a[44:47], a[140:143], v[180:183]
    ds_read_b128 a[92:95], v206 offset:6144
    v_mfma_f32_16x16x32_bf16 v[56:59], a[48:51], a[104:107], v[56:59]
    v_mfma_f32_16x16x32_bf16 v[56:59], a[52:55], a[108:111], v[56:59]
    ds_read_b64_tr_b16 a[40:41], v212 offset:0
    s_xor_b32 s92, s64, 16384
    v_mfma_f32_16x16x32_bf16 v[88:91], a[48:51], a[112:115], v[88:91]
    ds_read_b128 a[96:99], v205 offset:8192
    v_mfma_f32_16x16x32_bf16 v[88:91], a[52:55], a[116:119], v[88:91]
    ds_read_b64_tr_b16 a[42:43], v212 offset:2048
    v_mfma_f32_16x16x32_bf16 v[120:123], a[48:51], a[120:123], v[120:123]
    s_add_u32 m0, s95, 0
    v_mfma_f32_16x16x32_bf16 v[120:123], a[52:55], a[124:127], v[120:123]
    v_mfma_f32_16x16x32_bf16 v[152:155], a[48:51], a[128:131], v[152:155]
    ds_read_b64_tr_b16 a[44:45], v212 offset:16384
    v_mfma_f32_16x16x32_bf16 v[152:155], a[52:55], a[132:135], v[152:155]
    ds_read_b128 a[100:103], v206 offset:8192
    v_mfma_f32_16x16x32_bf16 v[184:187], a[48:51], a[136:139], v[184:187]
    buffer_load_dwordx4 v1, s[16:19], s92 offen offset:0 nt lds
    v_mfma_f32_16x16x32_bf16 v[184:187], a[52:55], a[140:143], v[184:187]
    ds_read_b64_tr_b16 a[46:47], v212 offset:18432
    v_mfma_f32_16x16x32_bf16 v[60:63], a[56:59], a[104:107], v[60:63]
    v_mfma_f32_16x16x32_bf16 v[60:63], a[60:63], a[108:111], v[60:63]
    ds_read_b64_tr_b16 a[48:49], v213 offset:0
    v_mfma_f32_16x16x32_bf16 v[92:95], a[56:59], a[112:115], v[92:95]
    buffer_load_dwordx4 v2, s[16:19], s92 offen offset:1024 nt lds
    v_mfma_f32_16x16x32_bf16 v[92:95], a[60:63], a[116:119], v[92:95]
    ds_read_b64_tr_b16 a[50:51], v213 offset:2048
    v_mfma_f32_16x16x32_bf16 v[124:127], a[56:59], a[120:123], v[124:127]
    v_mfma_f32_16x16x32_bf16 v[124:127], a[60:63], a[124:127], v[124:127]
    buffer_load_dwordx4 v3, s[16:19], s92 offen offset:2048 nt lds
    v_mfma_f32_16x16x32_bf16 v[156:159], a[56:59], a[128:131], v[156:159]
    ds_read_b64_tr_b16 a[52:53], v213 offset:16384
    v_mfma_f32_16x16x32_bf16 v[156:159], a[60:63], a[132:135], v[156:159]
    v_mfma_f32_16x16x32_bf16 v[188:191], a[56:59], a[136:139], v[188:191]
    ds_read_b64_tr_b16 a[54:55], v213 offset:18432
    v_mfma_f32_16x16x32_bf16 v[188:191], a[60:63], a[140:143], v[188:191]
    buffer_load_dwordx4 v4, s[16:19], s92 offen offset:3072 nt lds
    s_waitcnt lgkmcnt(15)
    v_mfma_f32_16x16x32_bf16 v[32:35], a[0:3], a[64:67], v[32:35]
    v_mfma_f32_16x16x32_bf16 v[32:35], a[4:7], a[68:71], v[32:35]
    ds_read_b64_tr_b16 a[56:57], v214 offset:0
    v_mfma_f32_16x16x32_bf16 v[64:67], a[0:3], a[72:75], v[64:67]
    s_add_u32 m0, s95, 16384
    v_mfma_f32_16x16x32_bf16 v[64:67], a[4:7], a[76:79], v[64:67]
    ds_read_b64_tr_b16 a[58:59], v214 offset:2048
    v_mfma_f32_16x16x32_bf16 v[96:99], a[0:3], a[80:83], v[96:99]
    v_mfma_f32_16x16x32_bf16 v[96:99], a[4:7], a[84:87], v[96:99]
    ds_read_b64_tr_b16 a[60:61], v214 offset:16384
    s_waitcnt lgkmcnt(15)
    v_mfma_f32_16x16x32_bf16 v[128:131], a[0:3], a[88:91], v[128:131]
    buffer_load_dwordx4 v5, s[20:23], s92 offen offset:0 nt lds
    s_waitcnt lgkmcnt(13)
    v_mfma_f32_16x16x32_bf16 v[128:131], a[4:7], a[92:95], v[128:131]
    s_waitcnt lgkmcnt(11)
    v_mfma_f32_16x16x32_bf16 v[160:163], a[0:3], a[96:99], v[160:163]
    ds_read_b64_tr_b16 a[62:63], v214 offset:18432
    s_waitcnt lgkmcnt(9)
    v_mfma_f32_16x16x32_bf16 v[160:163], a[4:7], a[100:103], v[160:163]
    v_mfma_f32_16x16x32_bf16 v[36:39], a[8:11], a[64:67], v[36:39]
    buffer_load_dwordx4 v6, s[20:23], s92 offen offset:1024 nt lds
    v_mfma_f32_16x16x32_bf16 v[36:39], a[12:15], a[68:71], v[36:39]
    v_mfma_f32_16x16x32_bf16 v[68:71], a[8:11], a[72:75], v[68:71]
    v_mfma_f32_16x16x32_bf16 v[68:71], a[12:15], a[76:79], v[68:71]
    buffer_load_dwordx4 v5, s[20:23], s92 offen offset:2048 nt lds
    v_mfma_f32_16x16x32_bf16 v[100:103], a[8:11], a[80:83], v[100:103]
    v_mfma_f32_16x16x32_bf16 v[100:103], a[12:15], a[84:87], v[100:103]
    v_mfma_f32_16x16x32_bf16 v[132:135], a[8:11], a[88:91], v[132:135]
    v_mfma_f32_16x16x32_bf16 v[132:135], a[12:15], a[92:95], v[132:135]
    buffer_load_dwordx4 v6, s[20:23], s92 offen offset:3072 nt lds
    v_mfma_f32_16x16x32_bf16 v[164:167], a[8:11], a[96:99], v[164:167]
    v_mfma_f32_16x16x32_bf16 v[164:167], a[12:15], a[100:103], v[164:167]
Lq_last:
    s_waitcnt lgkmcnt(0)
    s_barrier
    v_mfma_f32_16x16x32_bf16 v[40:43], a[16:19], a[64:67], v[40:43]
    v_mfma_f32_16x16x32_bf16 v[40:43], a[20:23], a[68:71], v[40:43]
    s_xor_b32 s92, s64, 24576
    v_mfma_f32_16x16x32_bf16 v[72:75], a[16:19], a[72:75], v[72:75]
    v_mul_f32 v32, s74, v32
    v_mul_f32 v33, s74, v33
    v_mfma_f32_16x16x32_bf16 v[72:75], a[20:23], a[76:79], v[72:75]
    v_mul_f32 v34, s74, v34
    v_mul_f32 v35, s74, v35
    v_mfma_f32_16x16x32_bf16 v[104:107], a[16:19], a[80:83], v[104:107]
    v_cvt_pk_bf16_f32 v32, v32, v33
    v_cvt_pk_bf16_f32 v33, v34, v35
    v_mfma_f32_16x16x32_bf16 v[104:107], a[20:23], a[84:87], v[104:107]
    ds_write_b64 v252, v[32:33] offset:0
    s_add_u32 m0, s95, 32768
    v_mul_f32 v36, s74, v36
    v_mfma_f32_16x16x32_bf16 v[136:139], a[16:19], a[88:91], v[136:139]
    v_mul_f32 v37, s74, v37
    v_mul_f32 v38, s74, v38
    v_mul_f32 v39, s74, v39
    v_mfma_f32_16x16x32_bf16 v[136:139], a[20:23], a[92:95], v[136:139]
    v_cvt_pk_bf16_f32 v36, v36, v37
    v_cvt_pk_bf16_f32 v37, v38, v39
    ds_write_b64 v252, v[36:37] offset:512
    ds_read_b128 a[104:107], v253 offset:0
    v_mul_f32 v64, s74, v64
    v_mul_f32 v65, s74, v65
    v_mul_f32 v66, s74, v66
    v_mfma_f32_16x16x32_bf16 v[168:171], a[16:19], a[96:99], v[168:171]
    buffer_load_dwordx4 v1, s[16:19], s92 offen offset:0 nt lds
    v_mfma_f32_16x16x32_bf16 v[168:171], a[20:23], a[100:103], v[168:171]
    v_mul_f32 v67, s74, v67
    v_cvt_pk_bf16_f32 v64, v64, v65
    v_cvt_pk_bf16_f32 v65, v66, v67
    v_mfma_f32_16x16x32_bf16 v[44:47], a[24:27], a[64:67], v[44:47]
    ds_write_b64 v252, v[64:65] offset:1024
    v_mul_f32 v68, s74, v68
    v_mul_f32 v69, s74, v69
    v_mfma_f32_16x16x32_bf16 v[44:47], a[28:31], a[68:71], v[44:47]
    v_mul_f32 v70, s74, v70
    v_mul_f32 v71, s74, v71
    v_cvt_pk_bf16_f32 v68, v68, v69
    v_cvt_pk_bf16_f32 v69, v70, v71
    v_mfma_f32_16x16x32_bf16 v[76:79], a[24:27], a[72:75], v[76:79]
    buffer_load_dwordx4 v2, s[16:19], s92 offen offset:1024 nt lds
    ds_write_b64 v252, v[68:69] offset:1536
    ds_read_b128 a[120:123], v253 offset:1024
    v_mul_f32 v96, s74, v96
    v_mfma_f32_16x16x32_bf16 v[76:79], a[28:31], a[76:79], v[76:79]
    v_mul_f32 v97, s74, v97
    v_mul_f32 v98, s74, v98
    v_mul_f32 v99, s74, v99
    v_mfma_f32_16x16x32_bf16 v[108:111], a[24:27], a[80:83], v[108:111]
    v_cvt_pk_bf16_f32 v96, v96, v97
    v_cvt_pk_bf16_f32 v97, v98, v99
    ds_write_b64 v252, v[96:97] offset:2048
    v_mul_f32 v100, s74, v100
    v_mul_f32 v101, s74, v101
    v_mul_f32 v102, s74, v102
    v_mul_f32 v103, s74, v103
    v_mfma_f32_16x16x32_bf16 v[108:111], a[28:31], a[84:87], v[108:111]
    buffer_load_dwordx4 v3, s[16:19], s92 offen offset:2048 nt lds
    v_mfma_f32_16x16x32_bf16 v[140:143], a[24:27], a[88:91], v[140:143]
    v_cvt_pk_bf16_f32 v100, v100, v101
    v_cvt_pk_bf16_f32 v101, v102, v103
    ds_write_b64 v252, v[100:101] offset:2560
    v_mfma_f32_16x16x32_bf16 v[140:143], a[28:31], a[92:95], v[140:143]
    ds_read_b128 a[136:139], v253 offset:2048
    v_mul_f32 v128, s74, v128
    v_mul_f32 v129, s74, v129
    v_mfma_f32_16x16x32_bf16 v[172:175], a[24:27], a[96:99], v[172:175]
    v_mul_f32 v130, s74, v130
    v_mul_f32 v131, s74, v131
    v_cvt_pk_bf16_f32 v128, v128, v129
    v_cvt_pk_bf16_f32 v129, v130, v131
    v_mfma_f32_16x16x32_bf16 v[172:175], a[28:31], a[100:103], v[172:175]
    buffer_load_dwordx4 v4, s[16:19], s92 offen offset:3072 nt lds
    ds_write_b64 v252, v[128:129] offset:3072
    v_mul_f32 v132, s74, v132
    v_mul_f32 v133, s74, v133
    v_mfma_f32_16x16x32_bf16 v[48:51], a[32:35], a[64:67], v[48:51]
    s_waitcnt vmcnt(20)
    s_barrier
    v_mul_f32 v134, s74, v134
    v_mul_f32 v135, s74, v135
    v_cvt_pk_bf16_f32 v132, v132, v133
    v_mfma_f32_16x16x32_bf16 v[48:51], a[36:39], a[68:71], v[48:51]
    v_cvt_pk_bf16_f32 v133, v134, v135
    ds_write_b64 v252, v[132:133] offset:3584
    ds_read_b128 a[152:155], v253 offset:3072
    v_mfma_f32_16x16x32_bf16 v[80:83], a[32:35], a[72:75], v[80:83]
    ds_read_b128 a[184:187], v7 offset:0
    v_mul_f32 v160, s74, v160
    v_mul_f32 v161, s74, v161
    v_mul_f32 v162, s74, v162
    v_mul_f32 v163, s74, v163
    v_mfma_f32_16x16x32_bf16 v[80:83], a[36:39], a[76:79], v[80:83]
    v_cvt_pk_bf16_f32 v160, v160, v161
    v_cvt_pk_bf16_f32 v161, v162, v163
    ds_write_b64 v252, v[160:161] offset:0
    v_mfma_f32_16x16x32_bf16 v[112:115], a[32:35], a[80:83], v[112:115]
    v_mul_f32 v164, s74, v164
    v_mul_f32 v165, s74, v165
    v_mul_f32 v166, s74, v166
    v_mul_f32 v167, s74, v167
    v_cvt_pk_bf16_f32 v164, v164, v165
    v_cvt_pk_bf16_f32 v165, v166, v167
    ds_write_b64 v252, v[164:165] offset:512
    ds_read_b128 a[168:171], v253 offset:0
    v_mfma_f32_16x16x32_bf16 v[112:115], a[36:39], a[84:87], v[112:115]
    v_mul_f32 v40, s74, v40
    v_mul_f32 v41, s74, v41
    v_mfma_f32_16x16x32_bf16 v[144:147], a[32:35], a[88:91], v[144:147]
    v_mul_f32 v42, s74, v42
    v_mul_f32 v43, s74, v43
    v_cvt_pk_bf16_f32 v40, v40, v41
    v_mfma_f32_16x16x32_bf16 v[144:147], a[36:39], a[92:95], v[144:147]
    v_cvt_pk_bf16_f32 v41, v42, v43
    ds_write_b64 v252, v[40:41] offset:0
    v_mul_f32 v44, s74, v44
    v_mul_f32 v45, s74, v45
    v_mfma_f32_16x16x32_bf16 v[176:179], a[32:35], a[96:99], v[176:179]
    ds_read_b128 a[188:191], v8 offset:0
    v_mul_f32 v46, s74, v46
    v_mul_f32 v47, s74, v47
    v_cvt_pk_bf16_f32 v44, v44, v45
    v_mfma_f32_16x16x32_bf16 v[176:179], a[36:39], a[100:103], v[176:179]
    v_cvt_pk_bf16_f32 v45, v46, v47
    ds_write_b64 v252, v[44:45] offset:512
    ds_read_b128 a[108:111], v253 offset:0
    v_mul_f32 v72, s74, v72
    v_mfma_f32_16x16x32_bf16 v[52:55], a[40:43], a[64:67], v[52:55]
    v_mul_f32 v73, s74, v73
    v_mul_f32 v74, s74, v74
    v_mul_f32 v75, s74, v75
    v_cvt_pk_bf16_f32 v72, v72, v73
    v_mfma_f32_16x16x32_bf16 v[52:55], a[44:47], a[68:71], v[52:55]
    v_cvt_pk_bf16_f32 v73, v74, v75
    ds_write_b64 v252, v[72:73] offset:1024
    v_mul_f32 v76, s74, v76
    v_mfma_f32_16x16x32_bf16 v[84:87], a[40:43], a[72:75], v[84:87]
    ds_read_b128 a[192:195], v9 offset:0
    v_mul_f32 v77, s74, v77
    v_mul_f32 v78, s74, v78
    v_mul_f32 v79, s74, v79
    v_cvt_pk_bf16_f32 v76, v76, v77
    s_lshl3_add_u32 s96, s48, s49
    v_mfma_f32_16x16x32_bf16 v[84:87], a[44:47], a[76:79], v[84:87]
    v_cvt_pk_bf16_f32 v77, v78, v79
    ds_write_b64 v252, v[76:77] offset:1536
    ds_read_b128 a[124:127], v253 offset:1024
    v_mfma_f32_16x16x32_bf16 v[116:119], a[40:43], a[80:83], v[116:119]
    v_mul_f32 v104, s74, v104
    v_mul_f32 v105, s74, v105
    v_mul_f32 v106, s74, v106
    v_mul_f32 v107, s74, v107
    v_mfma_f32_16x16x32_bf16 v[116:119], a[44:47], a[84:87], v[116:119]
    v_cvt_pk_bf16_f32 v104, v104, v105
    v_cvt_pk_bf16_f32 v105, v106, v107
    ds_write_b64 v252, v[104:105] offset:2048
    v_mfma_f32_16x16x32_bf16 v[148:151], a[40:43], a[88:91], v[148:151]
    ds_read_b128 a[196:199], v10 offset:0
    v_mul_f32 v108, s74, v108
    v_mul_f32 v109, s74, v109
    v_mul_f32 v110, s74, v110
    v_mul_f32 v111, s74, v111
    v_mfma_f32_16x16x32_bf16 v[148:151], a[44:47], a[92:95], v[148:151]
    v_cvt_pk_bf16_f32 v108, v108, v109
    v_cvt_pk_bf16_f32 v109, v110, v111
    ds_write_b64 v252, v[108:109] offset:2560
    ds_read_b128 a[140:143], v253 offset:2048
    v_mfma_f32_16x16x32_bf16 v[180:183], a[40:43], a[96:99], v[180:183]
    v_mul_f32 v136, s74, v136
    v_mul_f32 v137, s74, v137
    v_mul_f32 v138, s74, v138
    s_lshl4_add_u32 s96, s96, s50
    v_mfma_f32_16x16x32_bf16 v[180:183], a[44:47], a[100:103], v[180:183]
    v_mul_f32 v139, s74, v139
    v_cvt_pk_bf16_f32 v136, v136, v137
    v_cvt_pk_bf16_f32 v137, v138, v139
    ds_write_b64 v252, v[136:137] offset:3072
    v_mfma_f32_16x16x32_bf16 v[56:59], a[48:51], a[64:67], v[56:59]
    ds_read_b128 a[200:203], v7 offset:4096
    v_mul_f32 v140, s74, v140
    v_mul_f32 v141, s74, v141
    v_mul_f32 v142, s74, v142
    v_mfma_f32_16x16x32_bf16 v[56:59], a[52:55], a[68:71], v[56:59]
    v_mul_f32 v143, s74, v143
    v_cvt_pk_bf16_f32 v140, v140, v141
    v_cvt_pk_bf16_f32 v141, v142, v143
    ds_write_b64 v252, v[140:141] offset:3584
    v_mfma_f32_16x16x32_bf16 v[88:91], a[48:51], a[72:75], v[88:91]
    ds_read_b128 a[156:159], v253 offset:3072
    v_mul_f32 v168, s74, v168
    v_mul_f32 v169, s74, v169
    v_mfma_f32_16x16x32_bf16 v[88:91], a[52:55], a[76:79], v[88:91]
    v_mul_f32 v170, s74, v170
    v_mul_f32 v171, s74, v171
    v_cvt_pk_bf16_f32 v168, v168, v169
    v_cvt_pk_bf16_f32 v169, v170, v171
    v_mfma_f32_16x16x32_bf16 v[120:123], a[48:51], a[80:83], v[120:123]
    ds_write_b64 v252, v[168:169] offset:0
    v_mul_f32 v172, s74, v172
    v_mul_f32 v173, s74, v173
    v_mul_f32 v174, s74, v174
    v_mul_f32 v175, s74, v175
    v_cvt_pk_bf16_f32 v172, v172, v173
    v_cvt_pk_bf16_f32 v173, v174, v175
    ds_write_b64 v252, v[172:173] offset:512
    ds_read_b128 a[172:175], v253 offset:0
    v_lshl_add_u32 v26, v0, 24, s96
    v_mfma_f32_16x16x32_bf16 v[120:123], a[52:55], a[84:87], v[120:123]
    ds_read_b128 a[204:207], v8 offset:4096
    v_mul_f32 v48, s74, v48
    v_mul_f32 v49, s74, v49
    v_mfma_f32_16x16x32_bf16 v[152:155], a[48:51], a[88:91], v[152:155]
    v_mul_f32 v50, s74, v50
    v_mul_f32 v51, s74, v51
    v_cvt_pk_bf16_f32 v48, v48, v49
    v_cvt_pk_bf16_f32 v49, v50, v51
    ds_write_b64 v252, v[48:49] offset:0
    v_mfma_f32_16x16x32_bf16 v[152:155], a[52:55], a[92:95], v[152:155]
    v_mul_f32 v52, s74, v52
    v_mul_f32 v53, s74, v53
    v_mul_f32 v54, s74, v54
    v_mul_f32 v55, s74, v55
    v_cvt_pk_bf16_f32 v52, v52, v53
    v_mfma_f32_16x16x32_bf16 v[184:187], a[48:51], a[96:99], v[184:187]
    v_cvt_pk_bf16_f32 v53, v54, v55
    ds_write_b64 v252, v[52:53] offset:512
    ds_read_b128 a[112:115], v253 offset:0
    v_mul_f32 v80, s74, v80
    v_mfma_f32_16x16x32_bf16 v[184:187], a[52:55], a[100:103], v[184:187]
    ds_read_b128 a[208:211], v9 offset:4096
    v_mul_f32 v81, s74, v81
    v_mul_f32 v82, s74, v82
    v_mul_f32 v83, s74, v83
    v_cvt_pk_bf16_f32 v80, v80, v81
    v_cvt_pk_bf16_f32 v81, v82, v83
    v_mfma_f32_16x16x32_bf16 v[60:63], a[56:59], a[64:67], v[60:63]
    ds_write_b64 v252, v[80:81] offset:1024
    v_mul_f32 v84, s74, v84
    v_mul_f32 v85, s74, v85
    v_mul_f32 v86, s74, v86
    v_mul_f32 v87, s74, v87
    v_mov_b32 v27, 1
    v_mfma_f32_16x16x32_bf16 v[60:63], a[60:63], a[68:71], v[60:63]
    v_cvt_pk_bf16_f32 v84, v84, v85
    v_cvt_pk_bf16_f32 v85, v86, v87
    ds_write_b64 v252, v[84:85] offset:1536
    ds_read_b128 a[128:131], v253 offset:1024
    v_mfma_f32_16x16x32_bf16 v[92:95], a[56:59], a[72:75], v[92:95]
    v_mul_f32 v112, s74, v112
    v_mul_f32 v113, s74, v113
    v_mul_f32 v114, s74, v114
    v_mul_f32 v115, s74, v115
    v_cvt_pk_bf16_f32 v112, v112, v113
    v_mfma_f32_16x16x32_bf16 v[92:95], a[60:63], a[76:79], v[92:95]
    v_cvt_pk_bf16_f32 v113, v114, v115
    ds_write_b64 v252, v[112:113] offset:2048
    v_mul_f32 v116, s74, v116
    v_mul_f32 v117, s74, v117
    v_mul_f32 v118, s74, v118
    v_mfma_f32_16x16x32_bf16 v[124:127], a[56:59], a[80:83], v[124:127]
    v_mul_f32 v119, s74, v119
    v_cvt_pk_bf16_f32 v116, v116, v117
    v_cvt_pk_bf16_f32 v117, v118, v119
    ds_write_b64 v252, v[116:117] offset:2560
    ds_read_b128 a[144:147], v253 offset:2048
    v_mfma_f32_16x16x32_bf16 v[124:127], a[60:63], a[84:87], v[124:127]
    ds_read_b128 a[212:215], v10 offset:4096
    buffer_store_byte v27, v26, s[36:39], s83 offen sc1
    v_mul_f32 v144, s74, v144
    v_mul_f32 v145, s74, v145
    v_mul_f32 v146, s74, v146
    v_mul_f32 v147, s74, v147
    v_mfma_f32_16x16x32_bf16 v[156:159], a[56:59], a[88:91], v[156:159]
    v_cvt_pk_bf16_f32 v144, v144, v145
    v_cvt_pk_bf16_f32 v145, v146, v147
    ds_write_b64 v252, v[144:145] offset:3072
    v_mul_f32 v148, s74, v148
    v_mul_f32 v149, s74, v149
    v_mfma_f32_16x16x32_bf16 v[156:159], a[60:63], a[92:95], v[156:159]
    v_mul_f32 v150, s74, v150
    v_mul_f32 v151, s74, v151
    v_cvt_pk_bf16_f32 v148, v148, v149
    v_cvt_pk_bf16_f32 v149, v150, v151
    ds_write_b64 v252, v[148:149] offset:3584
    v_mfma_f32_16x16x32_bf16 v[188:191], a[56:59], a[96:99], v[188:191]
    ds_read_b128 a[160:163], v253 offset:3072
    v_mul_f32 v176, s74, v176
    v_mul_f32 v177, s74, v177
    v_mul_f32 v178, s74, v178
    v_mfma_f32_16x16x32_bf16 v[188:191], a[60:63], a[100:103], v[188:191]
    v_mul_f32 v179, s74, v179
    v_cvt_pk_bf16_f32 v176, v176, v177
    v_cvt_pk_bf16_f32 v177, v178, v179
    ds_write_b64 v252, v[176:177] offset:0
    v_mul_f32 v180, s74, v180
    v_mul_f32 v181, s74, v181
    v_mul_f32 v182, s74, v182
    v_mul_f32 v183, s74, v183
    v_cvt_pk_bf16_f32 v180, v180, v181
    v_cvt_pk_bf16_f32 v181, v182, v183
    ds_write_b64 v252, v[180:181] offset:512
    ds_read_b128 a[176:179], v253 offset:0
    v_mul_f32 v56, s74, v56
    v_mul_f32 v57, s74, v57
    v_mul_f32 v58, s74, v58
    v_mul_f32 v59, s74, v59
    v_cvt_pk_bf16_f32 v56, v56, v57
    v_cvt_pk_bf16_f32 v57, v58, v59
    ds_write_b64 v252, v[56:57] offset:0
    v_mul_f32 v60, s74, v60
    v_mul_f32 v61, s74, v61
    v_mul_f32 v62, s74, v62
    v_mul_f32 v63, s74, v63
    v_cvt_pk_bf16_f32 v60, v60, v61
    v_cvt_pk_bf16_f32 v61, v62, v63
    ds_write_b64 v252, v[60:61] offset:512
    ds_read_b128 a[116:119], v253 offset:0
    s_mov_b32 s80, 32768
    s_mov_b32 s81, 65536
    s_mov_b32 s7, 0
    s_mov_b32 s3, 0xffffc040
    s_waitcnt vmcnt(16) lgkmcnt(0)
    s_barrier
    v_mfma_f32_16x16x32_bf16 v[228:231], a[184:187], a[104:107], 0
    v_mul_f32 v88, s74, v88
    v_mul_f32 v89, s74, v89
    v_mfma_f32_16x16x32_bf16 v[228:231], a[188:191], a[108:111], v[228:231]
    ds_read_b64_tr_b16 a[216:217], v11 offset:0
    v_mul_f32 v90, s74, v90
    v_mul_f32 v91, s74, v91
    s_sub_u32 s63, s80, 0x2000
    v_mfma_f32_16x16x32_bf16 v[228:231], a[192:195], a[112:115], v[228:231]
    ds_read_b64_tr_b16 a[218:219], v11 offset:4096
    v_cvt_pk_bf16_f32 v88, v88, v89
    v_cvt_pk_bf16_f32 v89, v90, v91
    v_mfma_f32_16x16x32_bf16 v[228:231], a[196:199], a[116:119], v[228:231]
    ds_write_b64 v252, v[88:89] offset:1024
    v_mul_f32 v92, s74, v92
    s_xor_b32 s63, s63, s64
    v_mfma_f32_16x16x32_bf16 v[232:235], a[200:203], a[104:107], 0
    ds_read_b64_tr_b16 a[220:221], v12 offset:0
    v_mul_f32 v93, s74, v93
    v_mul_f32 v94, s74, v94
    v_mul_f32 v120, s74, v120
    v_mfma_f32_16x16x32_bf16 v[232:235], a[204:207], a[108:111], v[232:235]
    v_mul_f32 v95, s74, v95
    v_cvt_pk_bf16_f32 v92, v92, v93
    v_cvt_pk_bf16_f32 v93, v94, v95
    ds_write_b64 v252, v[92:93] offset:1536
    ds_read_b128 a[132:135], v253 offset:1024
    v_mfma_f32_16x16x32_bf16 v[232:235], a[208:211], a[112:115], v[232:235]
    v_mul_f32 v121, s74, v121
    v_mul_f32 v122, s74, v122
    v_mfma_f32_16x16x32_bf16 v[232:235], a[212:215], a[116:119], v[232:235]
    ds_read_b64_tr_b16 a[222:223], v12 offset:4096
    v_mul_f32 v123, s74, v123
    v_cvt_pk_bf16_f32 v120, v120, v121
    v_mfma_f32_16x16x32_bf16 v[236:239], a[184:187], a[120:123], 0
    ds_read_b64_tr_b16 a[224:225], v13 offset:0
    v_cvt_pk_bf16_f32 v121, v122, v123
    s_xor_b32 s62, s80, s64
    v_mfma_f32_16x16x32_bf16 v[236:239], a[188:191], a[124:127], v[236:239]
    ds_write_b64 v252, v[120:121] offset:2048
    v_mul_f32 v124, s74, v124
    s_add_u32 s61, s81, 98304
    v_mfma_f32_16x16x32_bf16 v[236:239], a[192:195], a[128:131], v[236:239]
    v_mul_f32 v125, s74, v125
    v_mul_f32 v126, s74, v126
    v_max3_f32 v28, v228, v229, v230
    s_waitcnt lgkmcnt(3)
    v_mfma_f32_16x16x32_bf16 v[236:239], a[196:199], a[132:135], v[236:239]
    ds_read_b64_tr_b16 a[226:227], v13 offset:4096
    v_mul_f32 v127, s74, v127
    v_cvt_pk_bf16_f32 v124, v124, v125
    s_bitcmp0_b32 s3, s7
    s_cselect_b32 s55, s63, 0x40000000
    s_cselect_b32 s92, s62, 0x40000000
    v_max3_f32 v29, v231, v232, v233
    v_mfma_f32_16x16x32_bf16 v[240:243], a[200:203], a[120:123], 0
    v_cvt_pk_bf16_f32 v125, v126, v127
    v_mul_f32 v152, s74, v152
    v_max3_f32 v28, v28, v234, v235
    v_max3_f32 v28, v28, v29, v19
    v_mfma_f32_16x16x32_bf16 v[240:243], a[204:207], a[124:127], v[240:243]
    ds_write_b64 v252, v[124:125] offset:2560
    ds_read_b128 a[148:151], v253 offset:2048
    ds_read_b64_tr_b16 a[228:229], v14 offset:0
    v_mov_b32 v29, v28
    v_mfma_f32_16x16x32_bf16 v[240:243], a[208:211], a[128:131], v[240:243]
    v_mul_f32 v153, s74, v153
    v_mul_f32 v154, s74, v154
    v_permlane16_swap_b32 v28, v29
    v_mfma_f32_16x16x32_bf16 v[240:243], a[212:215], a[132:135], v[240:243]
    ds_read_b64_tr_b16 a[230:231], v14 offset:4096
    v_mul_f32 v155, s74, v155
    v_cvt_pk_bf16_f32 v152, v152, v153
    v_max_f32 v28, v28, v29
    v_mfma_f32_16x16x32_bf16 v[244:247], a[184:187], a[136:139], 0
    v_cvt_pk_bf16_f32 v153, v154, v155
    s_and_b32 s61, s61, 0x1ffff
    v_mov_b32 v29, v28
    s_nop 1
    v_permlane32_swap_b32 v28, v29
    v_mfma_f32_16x16x32_bf16 v[244:247], a[188:191], a[140:143], v[244:247]
    ds_write_b64 v252, v[152:153] offset:3072
    v_mul_f32 v156, s74, v156
    s_add_u32 s61, s61, s95
    v_max_f32 v28, v28, v29
    v_mfma_f32_16x16x32_bf16 v[244:247], a[192:195], a[144:147], v[244:247]
    ds_read_b64_tr_b16 a[232:233], v15 offset:0
    v_mul_f32 v157, s74, v157
    v_mul_f32 v158, s74, v158
    v_sub_f32 v228, v228, v28
    s_waitcnt lgkmcnt(4)
    v_mfma_f32_16x16x32_bf16 v[244:247], a[196:199], a[148:151], v[244:247]
    ds_read_b64_tr_b16 a[234:235], v15 offset:4096
    v_mul_f32 v159, s74, v159
    v_cvt_pk_bf16_f32 v156, v156, v157
    s_add_u32 m0, s61, 16384
    v_sub_f32 v229, v229, v28
    v_mfma_f32_16x16x32_bf16 v[248:251], a[200:203], a[136:139], 0
    v_cvt_pk_bf16_f32 v157, v158, v159
    v_mul_f32 v184, s74, v184
    v_sub_f32 v230, v230, v28
    v_mfma_f32_16x16x32_bf16 v[248:251], a[204:207], a[140:143], v[248:251]
    ds_write_b64 v252, v[156:157] offset:3584
    ds_read_b128 a[164:167], v253 offset:3072
    s_waitcnt vmcnt(6)
    buffer_load_dwordx4 v5, s[20:23], s55 offen offset:0 nt lds
    s_waitcnt vmcnt(6)
    buffer_load_dwordx4 v6, s[20:23], s55 offen offset:1024 nt lds
    ds_read_b64_tr_b16 a[236:237], v16 offset:0
    v_sub_f32 v231, v231, v28
    v_sub_f32 v232, v232, v28
    v_mfma_f32_16x16x32_bf16 v[248:251], a[208:211], a[144:147], v[248:251]
    v_mul_f32 v185, s74, v185
    v_mul_f32 v186, s74, v186
    v_mfma_f32_16x16x32_bf16 v[248:251], a[212:215], a[148:151], v[248:251]
    ds_read_b64_tr_b16 a[238:239], v16 offset:4096
    v_mul_f32 v187, s74, v187
    v_cvt_pk_bf16_f32 v184, v184, v185
    v_mfma_f32_16x16x32_bf16 v[200:203], a[184:187], a[152:155], 0
    v_cvt_pk_bf16_f32 v185, v186, v187
    v_sub_f32 v233, v233, v28
    v_sub_f32 v234, v234, v28
    v_sub_f32 v235, v235, v28
    v_mfma_f32_16x16x32_bf16 v[200:203], a[188:191], a[156:159], v[200:203]
    ds_write_b64 v252, v[184:185] offset:0
    v_mul_f32 v188, s74, v188
    v_sub_f32 v208, 0, v28
    v_mfma_f32_16x16x32_bf16 v[200:203], a[192:195], a[160:163], v[200:203]
    ds_read_b64_tr_b16 a[240:241], v17 offset:0
    v_mul_f32 v189, s74, v189
    v_mul_f32 v190, s74, v190
    v_sub_f32 v209, 0, v28
    s_waitcnt lgkmcnt(4)
    v_mfma_f32_16x16x32_bf16 v[200:203], a[196:199], a[164:167], v[200:203]
    ds_read_b64_tr_b16 a[242:243], v17 offset:4096
    v_mul_f32 v191, s74, v191
    v_cvt_pk_bf16_f32 v188, v188, v189
    v_mfma_f32_16x16x32_bf16 v[204:207], a[200:203], a[152:155], 0
    v_cvt_pk_bf16_f32 v189, v190, v191
    v_sub_f32 v210, 0, v28
    v_sub_f32 v211, 0, v28
    v_mfma_f32_16x16x32_bf16 v[204:207], a[204:207], a[156:159], v[204:207]
    ds_write_b64 v252, v[188:189] offset:512
    ds_read_b128 a[180:183], v253 offset:0
    ds_read_b64_tr_b16 a[244:245], v18 offset:0
    v_mfma_f32_16x16x32_bf16 v[204:207], a[208:211], a[160:163], v[204:207]
    s_waitcnt vmcnt(6)
    buffer_load_dwordx4 v5, s[20:23], s55 offen offset:2048 nt lds
    v_exp_f32 v228, v228
    v_exp_f32 v229, v229
    v_mfma_f32_16x16x32_bf16 v[204:207], a[212:215], a[164:167], v[204:207]
    s_waitcnt vmcnt(6)
    buffer_load_dwordx4 v6, s[20:23], s55 offen offset:3072 nt lds
    ds_read_b64_tr_b16 a[246:247], v18 offset:4096
    v_exp_f32 v230, v230
    v_mfma_f32_16x16x32_bf16 v[192:195], a[184:187], a[168:171], 0
    v_cvt_pk_bf16_f32 v228, v228, v229
    v_exp_f32 v231, v231
    v_mfma_f32_16x16x32_bf16 v[192:195], a[188:191], a[172:175], v[192:195]
    s_cmp_lt_u32 s92, 131072
    s_cselect_b32 s92, s92, 0x40000000
    v_mfma_f32_16x16x32_bf16 v[192:195], a[192:195], a[176:179], v[192:195]
    ds_read_b128 a[0:3], v7 offset:32768
    v_exp_f32 v232, v232
    v_cvt_pk_bf16_f32 v229, v230, v231
    v_mov_b64 v[160:161], 0
    s_waitcnt lgkmcnt(3)
    v_mfma_f32_16x16x32_bf16 v[192:195], a[196:199], a[180:183], v[192:195]
    s_add_u32 m0, s81, s95
    v_exp_f32 v233, v233
    v_mfma_f32_16x16x32_bf16 v[196:199], a[200:203], a[168:171], 0
    v_exp_f32 v234, v234
    v_mov_b64 v[162:163], 0
    v_mfma_f32_16x16x32_bf16 v[196:199], a[204:207], a[172:175], v[196:199]
    v_cvt_pk_bf16_f32 v230, v232, v233
    v_exp_f32 v235, v235
    s_nop 0
    v_cvt_pk_bf16_f32 v231, v234, v235
    v_max3_f32 v26, v236, v237, v238
    v_max3_f32 v27, v239, v240, v241
    v_mfma_f32_16x16x32_bf16 v[196:199], a[208:211], a[176:179], v[196:199]
    s_waitcnt vmcnt(6)
    buffer_load_dwordx4 v1, s[16:19], s92 offen offset:0 nt lds
    ds_read_b128 a[4:7], v8 offset:32768
    v_mov_b64 v[164:165], 0
    v_mfma_f32_16x16x32_bf16 v[196:199], a[212:215], a[180:183], v[196:199]
    v_max3_f32 v26, v26, v242, v243
    v_max3_f32 v26, v26, v27, v20
    v_mov_b32 v27, v26
    v_mfma_f32_16x16x32_bf16 v[32:35], a[216:219], v[228:231], 0
    s_nop 0
    v_permlane16_swap_b32 v26, v27
    v_max_f32 v26, v26, v27
    v_mov_b32 v27, v26
    v_mov_b64 v[166:167], 0
    v_mfma_f32_16x16x32_bf16 v[36:39], a[220:223], v[228:231], 0
    s_waitcnt vmcnt(6)
    buffer_load_dwordx4 v2, s[16:19], s92 offen offset:1024 nt lds
    ds_read_b128 a[8:11], v9 offset:32768
    v_permlane32_swap_b32 v26, v27
    v_max_f32 v26, v26, v27
    v_sub_f32 v236, v236, v26
    v_sub_f32 v237, v237, v26
    v_mfma_f32_16x16x32_bf16 v[40:43], a[224:227], v[228:231], 0
    v_sub_f32 v238, v238, v26
    v_sub_f32 v239, v239, v26
    v_sub_f32 v240, v240, v26
    v_sub_f32 v241, v241, v26
    v_sub_f32 v242, v242, v26
    v_sub_f32 v243, v243, v26
    v_sub_f32 v212, 0, v26
    v_mov_b64 v[168:169], 0
    v_mfma_f32_16x16x32_bf16 v[44:47], a[228:231], v[228:231], 0
    s_waitcnt vmcnt(6)
    buffer_load_dwordx4 v3, s[16:19], s92 offen offset:2048 nt lds
    v_mfma_f32_16x16x32_bf16 v[48:51], a[232:235], v[228:231], 0
    v_sub_f32 v213, 0, v26
    v_sub_f32 v214, 0, v26
    v_sub_f32 v215, 0, v26
    v_mov_b64 v[170:171], 0
    v_mfma_f32_16x16x32_bf16 v[52:55], a[236:239], v[228:231], 0
    ds_read_b128 a[12:15], v10 offset:32768
    v_exp_f32 v236, v236
    v_exp_f32 v237, v237
    v_exp_f32 v238, v238
    v_cvt_pk_bf16_f32 v236, v236, v237
    v_mfma_f32_16x16x32_bf16 v[56:59], a[240:243], v[228:231], 0
    s_waitcnt vmcnt(6)
    buffer_load_dwordx4 v4, s[16:19], s92 offen offset:3072 nt lds
    v_exp_f32 v239, v239
    v_exp_f32 v240, v240
    v_cvt_pk_bf16_f32 v237, v238, v239
    v_exp_f32 v241, v241
    v_exp_f32 v242, v242
    v_cvt_pk_bf16_f32 v238, v240, v241
    v_exp_f32 v243, v243
    s_nop 0
    v_cvt_pk_bf16_f32 v239, v242, v243
    v_mov_b64 v[172:173], 0
    s_waitcnt lgkmcnt(4)
    v_mfma_f32_16x16x32_bf16 v[60:63], a[244:247], v[228:231], 0
    v_max3_f32 v28, v244, v245, v246
    v_max3_f32 v29, v247, v248, v249
    v_mfma_f32_16x16x32_bf16 a[64:67], a[248:251], v[228:231], 0
    ds_read_b128 a[16:19], v7 offset:36864
    v_max3_f32 v28, v28, v250, v251
    v_max3_f32 v28, v28, v29, v21
    v_mov_b32 v29, v28
    s_nop 1
    v_permlane16_swap_b32 v28, v29
    v_max_f32 v28, v28, v29
    v_mov_b32 v29, v28
    v_mfma_f32_16x16x32_bf16 v[64:67], a[216:219], v[236:239], 0
    s_bitcmp0_b32 s3, s7
    s_cselect_b32 s62, 0x2000, 0
    v_mov_b64 v[174:175], 0
    v_mfma_f32_16x16x32_bf16 v[68:71], a[220:223], v[236:239], 0
    v_permlane32_swap_b32 v28, v29
    v_max_f32 v28, v28, v29
    v_sub_f32 v244, v244, v28
    v_sub_f32 v245, v245, v28
    v_mfma_f32_16x16x32_bf16 v[72:75], a[224:227], v[236:239], 0
    s_add_u32 s80, s80, s62
    v_sub_f32 v246, v246, v28
    v_sub_f32 v247, v247, v28
    v_sub_f32 v248, v248, v28
    v_mov_b64 v[176:177], 0
    v_mfma_f32_16x16x32_bf16 v[76:79], a[228:231], v[236:239], 0
    ds_read_b128 a[20:23], v8 offset:36864
    v_sub_f32 v249, v249, v28
    v_sub_f32 v250, v250, v28
    v_sub_f32 v251, v251, v28
    v_sub_f32 v216, 0, v28
    v_mfma_f32_16x16x32_bf16 v[80:83], a[232:235], v[236:239], 0
    v_sub_f32 v217, 0, v28
    v_sub_f32 v218, 0, v28
    v_sub_f32 v219, 0, v28
    v_mov_b64 v[178:179], 0
    v_mfma_f32_16x16x32_bf16 v[84:87], a[236:239], v[236:239], 0
    s_lshl2_add_u32 s81, s62, s81
    v_exp_f32 v244, v244
    v_exp_f32 v245, v245
    v_exp_f32 v246, v246
    v_mfma_f32_16x16x32_bf16 v[88:91], a[240:243], v[236:239], 0
    ds_read_b128 a[24:27], v9 offset:36864
    v_cvt_pk_bf16_f32 v244, v244, v245
    v_exp_f32 v247, v247
    v_exp_f32 v248, v248
    v_cvt_pk_bf16_f32 v245, v246, v247
    v_exp_f32 v249, v249
    v_exp_f32 v250, v250
    v_cvt_pk_bf16_f32 v246, v248, v249
    v_exp_f32 v251, v251
    s_nop 0
    v_cvt_pk_bf16_f32 v247, v250, v251
    v_mov_b64 v[180:181], 0
    v_mfma_f32_16x16x32_bf16 v[92:95], a[244:247], v[236:239], 0
    v_max3_f32 v26, v200, v201, v202
    v_max3_f32 v27, v203, v204, v205
    v_mfma_f32_16x16x32_bf16 a[68:71], a[248:251], v[236:239], 0
    s_and_b32 s81, s81, 0x1ffff
    v_max3_f32 v26, v26, v206, v207
    v_max3_f32 v26, v26, v27, v22
    v_mov_b32 v27, v26
    v_mov_b64 v[182:183], 0
    v_mfma_f32_16x16x32_bf16 v[96:99], a[216:219], v[244:247], 0
    v_permlane16_swap_b32 v26, v27
    v_max_f32 v26, v26, v27
    v_mov_b32 v27, v26
    v_mfma_f32_16x16x32_bf16 v[100:103], a[220:223], v[244:247], 0
    ds_read_b128 a[28:31], v10 offset:36864
    s_add_u32 s7, s7, 1
    v_permlane32_swap_b32 v26, v27
    v_max_f32 v26, v26, v27
    v_sub_f32 v200, v200, v26
    v_sub_f32 v201, v201, v26
    v_mov_b64 v[184:185], 0
    v_mfma_f32_16x16x32_bf16 v[104:107], a[224:227], v[244:247], 0
    v_sub_f32 v202, v202, v26
    v_sub_f32 v203, v203, v26
    v_sub_f32 v204, v204, v26
    v_mfma_f32_16x16x32_bf16 v[108:111], a[228:231], v[244:247], 0
    v_sub_f32 v205, v205, v26
    v_sub_f32 v206, v206, v26
    v_sub_f32 v207, v207, v26
    v_sub_f32 v220, 0, v26
    v_mfma_f32_16x16x32_bf16 v[112:115], a[232:235], v[244:247], 0
    v_sub_f32 v221, 0, v26
    v_sub_f32 v222, 0, v26
    v_sub_f32 v223, 0, v26
    v_mov_b64 v[186:187], 0
    v_mfma_f32_16x16x32_bf16 v[116:119], a[236:239], v[244:247], 0
    v_exp_f32 v200, v200
    v_exp_f32 v201, v201
    v_exp_f32 v202, v202
    v_xor_b32 v7, 0x10000, v7
    v_mfma_f32_16x16x32_bf16 v[120:123], a[240:243], v[244:247], 0
    v_cvt_pk_bf16_f32 v200, v200, v201
    v_exp_f32 v203, v203
    v_exp_f32 v204, v204
    v_cvt_pk_bf16_f32 v201, v202, v203
    v_exp_f32 v205, v205
    v_exp_f32 v206, v206
    v_cvt_pk_bf16_f32 v202, v204, v205
    v_exp_f32 v207, v207
    s_nop 0
    v_cvt_pk_bf16_f32 v203, v206, v207
    v_mov_b64 v[188:189], 0
    v_mfma_f32_16x16x32_bf16 v[124:127], a[244:247], v[244:247], 0
    v_max3_f32 v28, v192, v193, v194
    v_max3_f32 v29, v195, v196, v197
    v_mfma_f32_16x16x32_bf16 a[72:75], a[248:251], v[244:247], 0
    v_max3_f32 v28, v28, v198, v199
    v_max3_f32 v28, v28, v29, v23
    v_mov_b64 v[190:191], 0
    v_mfma_f32_16x16x32_bf16 v[128:131], a[216:219], v[200:203], 0
    v_mov_b32 v29, v28
    s_nop 1
    v_permlane16_swap_b32 v28, v29
    v_xor_b32 v8, 0x10000, v8
    v_mfma_f32_16x16x32_bf16 v[132:135], a[220:223], v[200:203], 0
    v_max_f32 v28, v28, v29
    v_mov_b32 v29, v28
    v_accvgpr_write_b32 a80, 0
    v_mfma_f32_16x16x32_bf16 v[136:139], a[224:227], v[200:203], 0
    v_permlane32_swap_b32 v28, v29
    v_max_f32 v28, v28, v29
    v_mfma_f32_16x16x32_bf16 v[140:143], a[228:231], v[200:203], 0
    v_sub_f32 v192, v192, v28
    v_sub_f32 v193, v193, v28
    v_sub_f32 v194, v194, v28
    v_accvgpr_write_b32 a81, 0
    v_xor_b32 v9, 0x10000, v9
    v_mfma_f32_16x16x32_bf16 v[144:147], a[232:235], v[200:203], 0
    v_sub_f32 v195, v195, v28
    v_sub_f32 v196, v196, v28
    v_mfma_f32_16x16x32_bf16 v[148:151], a[236:239], v[200:203], 0
    v_sub_f32 v197, v197, v28
    v_sub_f32 v198, v198, v28
    v_accvgpr_write_b32 a82, 0
    v_mfma_f32_16x16x32_bf16 v[152:155], a[240:243], v[200:203], 0
    v_sub_f32 v199, v199, v28
    v_sub_f32 v224, 0, v28
    v_sub_f32 v225, 0, v28
    v_mfma_f32_16x16x32_bf16 v[156:159], a[244:247], v[200:203], 0
    v_sub_f32 v226, 0, v28
    v_sub_f32 v227, 0, v28
    v_accvgpr_write_b32 a83, 0
    v_xor_b32 v10, 0x10000, v10
    v_mfma_f32_16x16x32_bf16 a[76:79], a[248:251], v[200:203], 0
    v_exp_f32 v192, v192
    v_exp_f32 v193, v193
    v_exp_f32 v194, v194
    v_cvt_pk_bf16_f32 v192, v192, v193
    v_exp_f32 v195, v195
    v_exp_f32 v196, v196
    v_lshrrev_b32 v228, 4, v0
    v_lshlrev_b32 v229, 1, v228
    v_xor_b32 v229, v229, v0
    v_and_b32 v229, 15, v229
    s_lshl_b32 s61, s4, 15
    v_lshl_add_u32 v228, v228, 11, s61
    v_lshl_add_u32 v228, v229, 4, v228
    v_xor_b32 v229, 128, v228
    v_add_u32 v230, 14336, v228
    v_add_u32 v231, 21504, v229
    v_add_u32 v229, 7168, v229
    v_lshlrev_b32 v26, 4, v0
    s_mul_i32 s61, s4, 5
    s_mul_i32 s90, s4, 5120
    s_add_u32 s62, s61, 0
    s_lshr_b32 s63, s62, 1
    s_lshl_b32 s63, s63, 7
    s_and_b32 s62, s62, 1
    s_add_u32 s62, s62, s63
    s_sub_u32 s62, s62, 0
    s_lshl_b32 s62, s62, 10
    v_add_u32 v232, s62, v26
    s_add_u32 s62, s61, 1
    s_lshr_b32 s63, s62, 1
    s_lshl_b32 s63, s63, 7
    s_and_b32 s62, s62, 1
    s_add_u32 s62, s62, s63
    s_sub_u32 s62, s62, 1
    s_lshl_b32 s62, s62, 10
    v_add_u32 v233, s62, v26
    s_add_u32 s62, s61, 2
    s_lshr_b32 s63, s62, 1
    s_lshl_b32 s63, s63, 7
    s_and_b32 s62, s62, 1
    s_add_u32 s62, s62, s63
    s_sub_u32 s62, s62, 2
    s_lshl_b32 s62, s62, 10
    v_add_u32 v234, s62, v26
    s_add_u32 s62, s61, 3
    s_lshr_b32 s63, s62, 1
    s_lshl_b32 s63, s63, 7
    s_and_b32 s62, s62, 1
    s_add_u32 s62, s62, s63
    s_sub_u32 s62, s62, 3
    s_lshl_b32 s62, s62, 10
    v_add_u32 v235, s62, v26
    s_add_u32 s62, s61, 4
    s_lshr_b32 s63, s62, 1
    s_lshl_b32 s63, s63, 7
    s_and_b32 s62, s62, 1
    s_add_u32 s62, s62, s63
    s_sub_u32 s62, s62, 0
    s_lshl_b32 s62, s62, 10
    v_add_u32 v236, s62, v26
    s_mul_i32 s61, s6, 10240
    s_add_u32 s61, s61, 65536
    v_add_u32 v241, s61, v26
    v_add_u32 v242, 40960, v241
    s_xor_b32 s61, s2, 2
    s_lshl2_add_u32 s61, s61, s4
    s_mul_i32 s61, s61, 10240
    v_add_u32 v244, s61, v26
    s_lshl2_add_u32 s61, s2, s4
    s_mul_i32 s61, s61, 10240
    v_add_u32 v243, s61, v26
    v_lshrrev_b32 v26, 2, v0
    v_and_b32 v27, 7, v26
    v_lshlrev_b32 v26, 8, v26
    v_and_b32 v28, 3, v0
    v_lshl_add_u32 v26, v28, 3, v26
    s_lshl_b32 s61, s5, 2
    s_lshl1_add_u32 s61, s51, s61
    v_xor_b32 v27, s61, v27
    v_lshl_add_u32 v237, v27, 5, v26
    v_xor_b32 v238, 32, v237
    v_xor_b32 v239, 64, v237
    v_xor_b32 v240, 96, v237
    v_and_b32 v26, 15, v0
    s_mul_i32 s61, s6, 327680
    s_lshl_b32 s62, s5, 7
    s_add_u32 s61, s61, s62
    s_lshl_b32 s62, s51, 6
    s_add_u32 s61, s61, s62
    v_lshl_add_u32 v26, v26, 12, s61
    v_bfe_u32 v27, v0, 4, 1
    v_lshl_add_u32 v26, v27, 5, v26
    v_lshrrev_b32 v27, 5, v0
    v_lshl_add_u32 v245, v27, 4, v26
    v_and_b32 v26, 3, v0
    v_bfe_u32 v27, v0, 2, 2
    v_lshl_add_u32 v26, v26, 3, v27
    s_lshl_b32 s61, s49, 5
    s_lshl2_add_u32 s61, s48, s61
    s_lshl_b32 s61, s61, 5
    s_add_u32 s61, s61, s50
    s_lshl_b32 s61, s61, 2
    v_lshl_add_u32 v26, v26, 7, s61
    v_and_b32 v27, 48, v0
    v_lshl_add_u32 v246, v27, 24, v26
    s_lshl_b32 s61, s2, 7
    v_lshl_add_u32 v26, v0, 2, s61
    v_and_b32 v27, 48, v0
    v_lshl_add_u32 v26, v27, 24, v26
    v_mov_b32 v247, v26
Lattn_loop:
    s_waitcnt vmcnt(8) lgkmcnt(0)
    s_barrier
    v_mfma_f32_16x16x32_bf16 v[200:203], a[0:3], a[104:107], v[208:211]
    v_cvt_pk_bf16_f32 v193, v194, v195
    s_sub_u32 s63, s80, 0x2000
    v_mfma_f32_16x16x32_bf16 v[200:203], a[4:7], a[108:111], v[200:203]
    v_exp_f32 v197, v197
    v_mfma_f32_16x16x32_bf16 v[200:203], a[8:11], a[112:115], v[200:203]
    ds_read_b64_tr_b16 a[32:33], v11 offset:32768
    ds_read_b64_tr_b16 a[34:35], v11 offset:36864
    v_mfma_f32_16x16x32_bf16 v[200:203], a[12:15], a[116:119], v[200:203]
    ds_read_b64_tr_b16 a[36:37], v12 offset:32768
    v_exp_f32 v198, v198
    v_mfma_f32_16x16x32_bf16 v[204:207], a[16:19], a[104:107], v[208:211]
    v_cvt_pk_bf16_f32 v194, v196, v197
    s_xor_b32 s63, s63, s64
    v_mfma_f32_16x16x32_bf16 v[204:207], a[20:23], a[108:111], v[204:207]
    v_exp_f32 v199, v199
    v_mfma_f32_16x16x32_bf16 v[204:207], a[24:27], a[112:115], v[204:207]
    ds_read_b64_tr_b16 a[38:39], v12 offset:36864
    v_cvt_pk_bf16_f32 v195, v198, v199
    v_mfma_f32_16x16x32_bf16 v[204:207], a[28:31], a[116:119], v[204:207]
    ds_read_b64_tr_b16 a[40:41], v13 offset:32768
    s_xor_b32 s62, s80, s64
    v_mfma_f32_16x16x32_bf16 v[160:163], a[216:219], v[192:195], v[160:163]
    ds_read_b64_tr_b16 a[42:43], v13 offset:36864
    v_exp_f32 v200, v200
    v_mfma_f32_16x16x32_bf16 v[164:167], a[220:223], v[192:195], v[164:167]
    ds_read_b64_tr_b16 a[44:45], v14 offset:32768
    s_add_u32 s61, s81, 98304
    v_mfma_f32_16x16x32_bf16 v[168:171], a[224:227], v[192:195], v[168:171]
    ds_read_b64_tr_b16 a[46:47], v14 offset:36864
    v_exp_f32 v201, v201
    v_mfma_f32_16x16x32_bf16 v[172:175], a[228:231], v[192:195], v[172:175]
    s_bitcmp0_b32 s3, s7
    s_cselect_b32 s55, s63, 0x40000000
    s_cselect_b32 s92, s62, 0x40000000
    v_mfma_f32_16x16x32_bf16 v[176:179], a[232:235], v[192:195], v[176:179]
    ds_read_b64_tr_b16 a[48:49], v15 offset:32768
    v_exp_f32 v202, v202
    v_mfma_f32_16x16x32_bf16 v[180:183], a[236:239], v[192:195], v[180:183]
    ds_read_b64_tr_b16 a[50:51], v15 offset:36864
    v_cvt_pk_bf16_f32 v200, v200, v201
    v_mfma_f32_16x16x32_bf16 v[184:187], a[240:243], v[192:195], v[184:187]
    v_exp_f32 v203, v203
    v_mfma_f32_16x16x32_bf16 v[188:191], a[244:247], v[192:195], v[188:191]
    ds_read_b64_tr_b16 a[52:53], v16 offset:32768
    s_and_b32 s61, s61, 0x1ffff
    v_mfma_f32_16x16x32_bf16 a[80:83], a[248:251], v[192:195], a[80:83]
    ds_read_b64_tr_b16 a[54:55], v16 offset:36864
    v_exp_f32 v204, v204
    v_mfma_f32_16x16x32_bf16 v[192:195], a[0:3], a[120:123], v[212:215]
    ds_read_b64_tr_b16 a[56:57], v17 offset:32768
    v_cvt_pk_bf16_f32 v201, v202, v203
    v_mfma_f32_16x16x32_bf16 v[192:195], a[4:7], a[124:127], v[192:195]
    v_exp_f32 v205, v205
    v_mfma_f32_16x16x32_bf16 v[192:195], a[8:11], a[128:131], v[192:195]
    ds_read_b64_tr_b16 a[58:59], v17 offset:36864
    s_add_u32 s61, s61, s95
    v_mfma_f32_16x16x32_bf16 v[192:195], a[12:15], a[132:135], v[192:195]
    ds_read_b64_tr_b16 a[60:61], v18 offset:32768
    ds_read_b64_tr_b16 a[62:63], v18 offset:36864
    v_exp_f32 v206, v206
    v_mfma_f32_16x16x32_bf16 v[196:199], a[16:19], a[120:123], v[212:215]
    v_cvt_pk_bf16_f32 v202, v204, v205
    s_add_u32 m0, s61, 16384
    v_mfma_f32_16x16x32_bf16 v[196:199], a[20:23], a[124:127], v[196:199]
    v_exp_f32 v207, v207
    v_mfma_f32_16x16x32_bf16 v[196:199], a[24:27], a[128:131], v[196:199]
    ds_read_b128 a[184:187], v7 offset:0
    v_cvt_pk_bf16_f32 v203, v206, v207
    v_mfma_f32_16x16x32_bf16 v[196:199], a[28:31], a[132:135], v[196:199]
    s_waitcnt vmcnt(6)
    buffer_load_dwordx4 v5, s[20:23], s55 offen offset:0 nt lds
    s_waitcnt lgkmcnt(15)
    v_mfma_f32_16x16x32_bf16 v[32:35], a[32:35], v[200:203], v[32:35]
    v_exp_f32 v192, v192
    s_waitcnt lgkmcnt(13)
    v_mfma_f32_16x16x32_bf16 v[36:39], a[36:39], v[200:203], v[36:39]
    s_waitcnt lgkmcnt(11)
    v_mfma_f32_16x16x32_bf16 v[40:43], a[40:43], v[200:203], v[40:43]
    v_exp_f32 v193, v193
    s_waitcnt lgkmcnt(9)
    v_mfma_f32_16x16x32_bf16 v[44:47], a[44:47], v[200:203], v[44:47]
    s_waitcnt vmcnt(6)
    buffer_load_dwordx4 v6, s[20:23], s55 offen offset:1024 nt lds
    s_waitcnt lgkmcnt(7)
    v_mfma_f32_16x16x32_bf16 v[48:51], a[48:51], v[200:203], v[48:51]
    v_exp_f32 v194, v194
    s_waitcnt lgkmcnt(5)
    v_mfma_f32_16x16x32_bf16 v[52:55], a[52:55], v[200:203], v[52:55]
    ds_read_b128 a[188:191], v8 offset:0
    v_cvt_pk_bf16_f32 v192, v192, v193
    s_waitcnt lgkmcnt(4)
    v_mfma_f32_16x16x32_bf16 v[56:59], a[56:59], v[200:203], v[56:59]
    v_exp_f32 v195, v195
    s_waitcnt lgkmcnt(2)
    v_mfma_f32_16x16x32_bf16 v[60:63], a[60:63], v[200:203], v[60:63]
    s_waitcnt vmcnt(6)
    buffer_load_dwordx4 v5, s[20:23], s55 offen offset:2048 nt lds
    v_mfma_f32_16x16x32_bf16 a[64:67], a[248:251], v[200:203], a[64:67]
    v_exp_f32 v196, v196
    v_xor_b32 v11, 0x10000, v11
    v_mfma_f32_16x16x32_bf16 v[200:203], a[0:3], a[136:139], v[216:219]
    ds_read_b128 a[192:195], v9 offset:0
    v_cvt_pk_bf16_f32 v193, v194, v195
    v_mfma_f32_16x16x32_bf16 v[200:203], a[4:7], a[140:143], v[200:203]
    v_exp_f32 v197, v197
    v_mfma_f32_16x16x32_bf16 v[200:203], a[8:11], a[144:147], v[200:203]
    s_waitcnt vmcnt(6)
    buffer_load_dwordx4 v6, s[20:23], s55 offen offset:3072 nt lds
    v_mfma_f32_16x16x32_bf16 v[200:203], a[12:15], a[148:151], v[200:203]
    v_exp_f32 v198, v198
    v_mfma_f32_16x16x32_bf16 v[204:207], a[16:19], a[136:139], v[216:219]
    v_cvt_pk_bf16_f32 v194, v196, v197
    v_xor_b32 v12, 0x10000, v12
    v_mfma_f32_16x16x32_bf16 v[204:207], a[20:23], a[140:143], v[204:207]
    v_exp_f32 v199, v199
    v_mfma_f32_16x16x32_bf16 v[204:207], a[24:27], a[144:147], v[204:207]
    ds_read_b128 a[196:199], v10 offset:0
    v_cvt_pk_bf16_f32 v195, v198, v199
    v_mfma_f32_16x16x32_bf16 v[204:207], a[28:31], a[148:151], v[204:207]
    s_cmp_lt_u32 s92, 131072
    s_cselect_b32 s92, s92, 0x40000000
    v_mfma_f32_16x16x32_bf16 v[64:67], a[32:35], v[192:195], v[64:67]
    v_exp_f32 v200, v200
    v_mfma_f32_16x16x32_bf16 v[68:71], a[36:39], v[192:195], v[68:71]
    v_mfma_f32_16x16x32_bf16 v[72:75], a[40:43], v[192:195], v[72:75]
    v_exp_f32 v201, v201
    v_mfma_f32_16x16x32_bf16 v[76:79], a[44:47], v[192:195], v[76:79]
    v_xor_b32 v13, 0x10000, v13
    v_mfma_f32_16x16x32_bf16 v[80:83], a[48:51], v[192:195], v[80:83]
    v_exp_f32 v202, v202
    v_mfma_f32_16x16x32_bf16 v[84:87], a[52:55], v[192:195], v[84:87]
    ds_read_b128 a[200:203], v7 offset:4096
    v_cvt_pk_bf16_f32 v200, v200, v201
    v_mfma_f32_16x16x32_bf16 v[88:91], a[56:59], v[192:195], v[88:91]
    v_exp_f32 v203, v203
    v_mfma_f32_16x16x32_bf16 v[92:95], a[60:63], v[192:195], v[92:95]
    v_mfma_f32_16x16x32_bf16 a[68:71], a[248:251], v[192:195], a[68:71]
    v_exp_f32 v204, v204
    v_mfma_f32_16x16x32_bf16 v[192:195], a[0:3], a[152:155], v[220:223]
    v_cvt_pk_bf16_f32 v201, v202, v203
    v_mfma_f32_16x16x32_bf16 v[192:195], a[4:7], a[156:159], v[192:195]
    v_exp_f32 v205, v205
    v_mfma_f32_16x16x32_bf16 v[192:195], a[8:11], a[160:163], v[192:195]
    ds_read_b128 a[204:207], v8 offset:4096
    s_add_u32 m0, s81, s95
    v_mfma_f32_16x16x32_bf16 v[192:195], a[12:15], a[164:167], v[192:195]
    v_exp_f32 v206, v206
    v_mfma_f32_16x16x32_bf16 v[196:199], a[16:19], a[152:155], v[220:223]
    v_cvt_pk_bf16_f32 v202, v204, v205
    v_xor_b32 v14, 0x10000, v14
    v_mfma_f32_16x16x32_bf16 v[196:199], a[20:23], a[156:159], v[196:199]
    v_exp_f32 v207, v207
    v_mfma_f32_16x16x32_bf16 v[196:199], a[24:27], a[160:163], v[196:199]
    ds_read_b128 a[208:211], v9 offset:4096
    v_cvt_pk_bf16_f32 v203, v206, v207
    v_mfma_f32_16x16x32_bf16 v[196:199], a[28:31], a[164:167], v[196:199]
    s_waitcnt vmcnt(6)
    buffer_load_dwordx4 v1, s[16:19], s92 offen offset:0 nt lds
    v_mfma_f32_16x16x32_bf16 v[96:99], a[32:35], v[200:203], v[96:99]
    v_exp_f32 v192, v192
    v_mfma_f32_16x16x32_bf16 v[100:103], a[36:39], v[200:203], v[100:103]
    v_xor_b32 v15, 0x10000, v15
    v_mfma_f32_16x16x32_bf16 v[104:107], a[40:43], v[200:203], v[104:107]
    v_exp_f32 v193, v193
    v_mfma_f32_16x16x32_bf16 v[108:111], a[44:47], v[200:203], v[108:111]
    s_waitcnt vmcnt(6)
    buffer_load_dwordx4 v2, s[16:19], s92 offen offset:1024 nt lds
    v_mfma_f32_16x16x32_bf16 v[112:115], a[48:51], v[200:203], v[112:115]
    v_exp_f32 v194, v194
    v_mfma_f32_16x16x32_bf16 v[116:119], a[52:55], v[200:203], v[116:119]
    ds_read_b128 a[212:215], v10 offset:4096
    v_cvt_pk_bf16_f32 v192, v192, v193
    v_mfma_f32_16x16x32_bf16 v[120:123], a[56:59], v[200:203], v[120:123]
    v_exp_f32 v195, v195
    v_mfma_f32_16x16x32_bf16 v[124:127], a[60:63], v[200:203], v[124:127]
    s_waitcnt vmcnt(6)
    buffer_load_dwordx4 v3, s[16:19], s92 offen offset:2048 nt lds
    v_mfma_f32_16x16x32_bf16 a[72:75], a[248:251], v[200:203], a[72:75]
    v_exp_f32 v196, v196
    v_mfma_f32_16x16x32_bf16 v[200:203], a[0:3], a[168:171], v[224:227]
    v_cvt_pk_bf16_f32 v193, v194, v195
    v_xor_b32 v16, 0x10000, v16
    v_mfma_f32_16x16x32_bf16 v[200:203], a[4:7], a[172:175], v[200:203]
    v_exp_f32 v197, v197
    v_mfma_f32_16x16x32_bf16 v[200:203], a[8:11], a[176:179], v[200:203]
    s_waitcnt vmcnt(6)
    buffer_load_dwordx4 v4, s[16:19], s92 offen offset:3072 nt lds
    v_mfma_f32_16x16x32_bf16 v[200:203], a[12:15], a[180:183], v[200:203]
    v_exp_f32 v198, v198
    v_mfma_f32_16x16x32_bf16 v[204:207], a[16:19], a[168:171], v[224:227]
    v_cvt_pk_bf16_f32 v194, v196, v197
    v_mfma_f32_16x16x32_bf16 v[204:207], a[20:23], a[172:175], v[204:207]
    v_exp_f32 v199, v199
    v_mfma_f32_16x16x32_bf16 v[204:207], a[24:27], a[176:179], v[204:207]
    v_cvt_pk_bf16_f32 v195, v198, v199
    v_xor_b32 v17, 0x10000, v17
    v_mfma_f32_16x16x32_bf16 v[204:207], a[28:31], a[180:183], v[204:207]
    s_bitcmp0_b32 s3, s7
    s_cselect_b32 s62, 0x2000, 0
    s_add_u32 s80, s80, s62
    v_mfma_f32_16x16x32_bf16 v[128:131], a[32:35], v[192:195], v[128:131]
    v_exp_f32 v200, v200
    v_mfma_f32_16x16x32_bf16 v[132:135], a[36:39], v[192:195], v[132:135]
    s_lshl2_add_u32 s81, s62, s81
    v_mfma_f32_16x16x32_bf16 v[136:139], a[40:43], v[192:195], v[136:139]
    v_exp_f32 v201, v201
    v_mfma_f32_16x16x32_bf16 v[140:143], a[44:47], v[192:195], v[140:143]
    v_mfma_f32_16x16x32_bf16 v[144:147], a[48:51], v[192:195], v[144:147]
    v_exp_f32 v202, v202
    v_mfma_f32_16x16x32_bf16 v[148:151], a[52:55], v[192:195], v[148:151]
    v_cvt_pk_bf16_f32 v200, v200, v201
    s_and_b32 s81, s81, 0x1ffff
    v_mfma_f32_16x16x32_bf16 v[152:155], a[56:59], v[192:195], v[152:155]
    v_exp_f32 v203, v203
    v_mfma_f32_16x16x32_bf16 v[156:159], a[60:63], v[192:195], v[156:159]
    s_add_u32 s7, s7, 1
    v_xor_b32 v18, 0x10000, v18
    v_mfma_f32_16x16x32_bf16 a[76:79], a[248:251], v[192:195], a[76:79]
    v_exp_f32 v204, v204
    s_waitcnt vmcnt(8) lgkmcnt(0)
    s_barrier
    v_mfma_f32_16x16x32_bf16 v[192:195], a[184:187], a[104:107], v[208:211]
    v_cvt_pk_bf16_f32 v201, v202, v203
    s_sub_u32 s63, s80, 0x2000
    v_mfma_f32_16x16x32_bf16 v[192:195], a[188:191], a[108:111], v[192:195]
    v_exp_f32 v205, v205
    v_mfma_f32_16x16x32_bf16 v[192:195], a[192:195], a[112:115], v[192:195]
    ds_read_b64_tr_b16 a[216:217], v11 offset:0
    ds_read_b64_tr_b16 a[218:219], v11 offset:4096
    v_mfma_f32_16x16x32_bf16 v[192:195], a[196:199], a[116:119], v[192:195]
    ds_read_b64_tr_b16 a[220:221], v12 offset:0
    v_exp_f32 v206, v206
    v_mfma_f32_16x16x32_bf16 v[196:199], a[200:203], a[104:107], v[208:211]
    v_cvt_pk_bf16_f32 v202, v204, v205
    s_xor_b32 s63, s63, s64
    v_mfma_f32_16x16x32_bf16 v[196:199], a[204:207], a[108:111], v[196:199]
    v_exp_f32 v207, v207
    v_mfma_f32_16x16x32_bf16 v[196:199], a[208:211], a[112:115], v[196:199]
    ds_read_b64_tr_b16 a[222:223], v12 offset:4096
    v_cvt_pk_bf16_f32 v203, v206, v207
    v_mfma_f32_16x16x32_bf16 v[196:199], a[212:215], a[116:119], v[196:199]
    ds_read_b64_tr_b16 a[224:225], v13 offset:0
    s_xor_b32 s62, s80, s64
    v_mfma_f32_16x16x32_bf16 v[160:163], a[32:35], v[200:203], v[160:163]
    ds_read_b64_tr_b16 a[226:227], v13 offset:4096
    v_exp_f32 v192, v192
    v_mfma_f32_16x16x32_bf16 v[164:167], a[36:39], v[200:203], v[164:167]
    ds_read_b64_tr_b16 a[228:229], v14 offset:0
    s_add_u32 s61, s81, 98304
    v_mfma_f32_16x16x32_bf16 v[168:171], a[40:43], v[200:203], v[168:171]
    ds_read_b64_tr_b16 a[230:231], v14 offset:4096
    v_exp_f32 v193, v193
    v_mfma_f32_16x16x32_bf16 v[172:175], a[44:47], v[200:203], v[172:175]
    s_bitcmp0_b32 s3, s7
    s_cselect_b32 s55, s63, 0x40000000
    s_cselect_b32 s92, s62, 0x40000000
    v_mfma_f32_16x16x32_bf16 v[176:179], a[48:51], v[200:203], v[176:179]
    ds_read_b64_tr_b16 a[232:233], v15 offset:0
    v_exp_f32 v194, v194
    v_mfma_f32_16x16x32_bf16 v[180:183], a[52:55], v[200:203], v[180:183]
    ds_read_b64_tr_b16 a[234:235], v15 offset:4096
    v_cvt_pk_bf16_f32 v192, v192, v193
    v_mfma_f32_16x16x32_bf16 v[184:187], a[56:59], v[200:203], v[184:187]
    v_exp_f32 v195, v195
    v_mfma_f32_16x16x32_bf16 v[188:191], a[60:63], v[200:203], v[188:191]
    ds_read_b64_tr_b16 a[236:237], v16 offset:0
    s_and_b32 s61, s61, 0x1ffff
    v_mfma_f32_16x16x32_bf16 a[80:83], a[248:251], v[200:203], a[80:83]
    ds_read_b64_tr_b16 a[238:239], v16 offset:4096
    v_exp_f32 v196, v196
    v_mfma_f32_16x16x32_bf16 v[200:203], a[184:187], a[120:123], v[212:215]
    ds_read_b64_tr_b16 a[240:241], v17 offset:0
    v_cvt_pk_bf16_f32 v193, v194, v195
    v_mfma_f32_16x16x32_bf16 v[200:203], a[188:191], a[124:127], v[200:203]
    v_exp_f32 v197, v197
    v_mfma_f32_16x16x32_bf16 v[200:203], a[192:195], a[128:131], v[200:203]
    ds_read_b64_tr_b16 a[242:243], v17 offset:4096
    s_add_u32 s61, s61, s95
    v_mfma_f32_16x16x32_bf16 v[200:203], a[196:199], a[132:135], v[200:203]
    ds_read_b64_tr_b16 a[244:245], v18 offset:0
    ds_read_b64_tr_b16 a[246:247], v18 offset:4096
    v_exp_f32 v198, v198
    v_mfma_f32_16x16x32_bf16 v[204:207], a[200:203], a[120:123], v[212:215]
    v_cvt_pk_bf16_f32 v194, v196, v197
    s_add_u32 m0, s61, 16384
    v_mfma_f32_16x16x32_bf16 v[204:207], a[204:207], a[124:127], v[204:207]
    v_exp_f32 v199, v199
    v_mfma_f32_16x16x32_bf16 v[204:207], a[208:211], a[128:131], v[204:207]
    ds_read_b128 a[0:3], v7 offset:32768
    v_cvt_pk_bf16_f32 v195, v198, v199
    v_mfma_f32_16x16x32_bf16 v[204:207], a[212:215], a[132:135], v[204:207]
    s_waitcnt vmcnt(6)
    buffer_load_dwordx4 v5, s[20:23], s55 offen offset:0 nt lds
    s_waitcnt lgkmcnt(15)
    v_mfma_f32_16x16x32_bf16 v[32:35], a[216:219], v[192:195], v[32:35]
    v_exp_f32 v200, v200
    s_waitcnt lgkmcnt(13)
    v_mfma_f32_16x16x32_bf16 v[36:39], a[220:223], v[192:195], v[36:39]
    s_waitcnt lgkmcnt(11)
    v_mfma_f32_16x16x32_bf16 v[40:43], a[224:227], v[192:195], v[40:43]
    v_exp_f32 v201, v201
    s_waitcnt lgkmcnt(9)
    v_mfma_f32_16x16x32_bf16 v[44:47], a[228:231], v[192:195], v[44:47]
    s_waitcnt vmcnt(6)
    buffer_load_dwordx4 v6, s[20:23], s55 offen offset:1024 nt lds
    s_waitcnt lgkmcnt(7)
    v_mfma_f32_16x16x32_bf16 v[48:51], a[232:235], v[192:195], v[48:51]
    v_exp_f32 v202, v202
    s_waitcnt lgkmcnt(5)
    v_mfma_f32_16x16x32_bf16 v[52:55], a[236:239], v[192:195], v[52:55]
    ds_read_b128 a[4:7], v8 offset:32768
    v_cvt_pk_bf16_f32 v200, v200, v201
    s_waitcnt lgkmcnt(4)
    v_mfma_f32_16x16x32_bf16 v[56:59], a[240:243], v[192:195], v[56:59]
    v_exp_f32 v203, v203
    s_waitcnt lgkmcnt(2)
    v_mfma_f32_16x16x32_bf16 v[60:63], a[244:247], v[192:195], v[60:63]
    s_waitcnt vmcnt(6)
    buffer_load_dwordx4 v5, s[20:23], s55 offen offset:2048 nt lds
    v_mfma_f32_16x16x32_bf16 a[64:67], a[248:251], v[192:195], a[64:67]
    v_exp_f32 v204, v204
    v_mfma_f32_16x16x32_bf16 v[192:195], a[184:187], a[136:139], v[216:219]
    ds_read_b128 a[8:11], v9 offset:32768
    v_cvt_pk_bf16_f32 v201, v202, v203
    v_mfma_f32_16x16x32_bf16 v[192:195], a[188:191], a[140:143], v[192:195]
    v_exp_f32 v205, v205
    v_mfma_f32_16x16x32_bf16 v[192:195], a[192:195], a[144:147], v[192:195]
    s_waitcnt vmcnt(6)
    buffer_load_dwordx4 v6, s[20:23], s55 offen offset:3072 nt lds
    v_mfma_f32_16x16x32_bf16 v[192:195], a[196:199], a[148:151], v[192:195]
    v_exp_f32 v206, v206
    v_mfma_f32_16x16x32_bf16 v[196:199], a[200:203], a[136:139], v[216:219]
    v_cvt_pk_bf16_f32 v202, v204, v205
    v_mfma_f32_16x16x32_bf16 v[196:199], a[204:207], a[140:143], v[196:199]
    v_exp_f32 v207, v207
    v_mfma_f32_16x16x32_bf16 v[196:199], a[208:211], a[144:147], v[196:199]
    ds_read_b128 a[12:15], v10 offset:32768
    v_cvt_pk_bf16_f32 v203, v206, v207
    v_mfma_f32_16x16x32_bf16 v[196:199], a[212:215], a[148:151], v[196:199]
    s_cmp_lt_u32 s92, 131072
    s_cselect_b32 s92, s92, 0x40000000
    v_mfma_f32_16x16x32_bf16 v[64:67], a[216:219], v[200:203], v[64:67]
    v_exp_f32 v192, v192
    v_mfma_f32_16x16x32_bf16 v[68:71], a[220:223], v[200:203], v[68:71]
    v_mfma_f32_16x16x32_bf16 v[72:75], a[224:227], v[200:203], v[72:75]
    v_exp_f32 v193, v193
    v_mfma_f32_16x16x32_bf16 v[76:79], a[228:231], v[200:203], v[76:79]
    v_mfma_f32_16x16x32_bf16 v[80:83], a[232:235], v[200:203], v[80:83]
    v_exp_f32 v194, v194
    v_mfma_f32_16x16x32_bf16 v[84:87], a[236:239], v[200:203], v[84:87]
    ds_read_b128 a[16:19], v7 offset:36864
    v_cvt_pk_bf16_f32 v192, v192, v193
    v_mfma_f32_16x16x32_bf16 v[88:91], a[240:243], v[200:203], v[88:91]
    v_exp_f32 v195, v195
    v_mfma_f32_16x16x32_bf16 v[92:95], a[244:247], v[200:203], v[92:95]
    v_mfma_f32_16x16x32_bf16 a[68:71], a[248:251], v[200:203], a[68:71]
    v_exp_f32 v196, v196
    v_mfma_f32_16x16x32_bf16 v[200:203], a[184:187], a[152:155], v[220:223]
    v_cvt_pk_bf16_f32 v193, v194, v195
    v_mfma_f32_16x16x32_bf16 v[200:203], a[188:191], a[156:159], v[200:203]
    v_exp_f32 v197, v197
    v_mfma_f32_16x16x32_bf16 v[200:203], a[192:195], a[160:163], v[200:203]
    ds_read_b128 a[20:23], v8 offset:36864
    s_add_u32 m0, s81, s95
    v_mfma_f32_16x16x32_bf16 v[200:203], a[196:199], a[164:167], v[200:203]
    v_exp_f32 v198, v198
    v_mfma_f32_16x16x32_bf16 v[204:207], a[200:203], a[152:155], v[220:223]
    v_cvt_pk_bf16_f32 v194, v196, v197
    v_mfma_f32_16x16x32_bf16 v[204:207], a[204:207], a[156:159], v[204:207]
    v_exp_f32 v199, v199
    v_mfma_f32_16x16x32_bf16 v[204:207], a[208:211], a[160:163], v[204:207]
    ds_read_b128 a[24:27], v9 offset:36864
    v_cvt_pk_bf16_f32 v195, v198, v199
    v_mfma_f32_16x16x32_bf16 v[204:207], a[212:215], a[164:167], v[204:207]
    s_waitcnt vmcnt(6)
    buffer_load_dwordx4 v1, s[16:19], s92 offen offset:0 nt lds
    v_mfma_f32_16x16x32_bf16 v[96:99], a[216:219], v[192:195], v[96:99]
    v_exp_f32 v200, v200
    v_mfma_f32_16x16x32_bf16 v[100:103], a[220:223], v[192:195], v[100:103]
    v_mfma_f32_16x16x32_bf16 v[104:107], a[224:227], v[192:195], v[104:107]
    v_exp_f32 v201, v201
    v_mfma_f32_16x16x32_bf16 v[108:111], a[228:231], v[192:195], v[108:111]
    s_waitcnt vmcnt(6)
    buffer_load_dwordx4 v2, s[16:19], s92 offen offset:1024 nt lds
    v_mfma_f32_16x16x32_bf16 v[112:115], a[232:235], v[192:195], v[112:115]
    v_exp_f32 v202, v202
    v_mfma_f32_16x16x32_bf16 v[116:119], a[236:239], v[192:195], v[116:119]
    ds_read_b128 a[28:31], v10 offset:36864
    v_cvt_pk_bf16_f32 v200, v200, v201
    v_mfma_f32_16x16x32_bf16 v[120:123], a[240:243], v[192:195], v[120:123]
    v_exp_f32 v203, v203
    v_mfma_f32_16x16x32_bf16 v[124:127], a[244:247], v[192:195], v[124:127]
    s_waitcnt vmcnt(6)
    buffer_load_dwordx4 v3, s[16:19], s92 offen offset:2048 nt lds
    v_mfma_f32_16x16x32_bf16 a[72:75], a[248:251], v[192:195], a[72:75]
    v_exp_f32 v204, v204
    v_mfma_f32_16x16x32_bf16 v[192:195], a[184:187], a[168:171], v[224:227]
    v_cvt_pk_bf16_f32 v201, v202, v203
    v_xor_b32 v7, 0x10000, v7
    v_mfma_f32_16x16x32_bf16 v[192:195], a[188:191], a[172:175], v[192:195]
    v_exp_f32 v205, v205
    v_mfma_f32_16x16x32_bf16 v[192:195], a[192:195], a[176:179], v[192:195]
    s_waitcnt vmcnt(6)
    buffer_load_dwordx4 v4, s[16:19], s92 offen offset:3072 nt lds
    v_mfma_f32_16x16x32_bf16 v[192:195], a[196:199], a[180:183], v[192:195]
    v_exp_f32 v206, v206
    v_mfma_f32_16x16x32_bf16 v[196:199], a[200:203], a[168:171], v[224:227]
    v_cvt_pk_bf16_f32 v202, v204, v205
    v_mfma_f32_16x16x32_bf16 v[196:199], a[204:207], a[172:175], v[196:199]
    v_exp_f32 v207, v207
    v_mfma_f32_16x16x32_bf16 v[196:199], a[208:211], a[176:179], v[196:199]
    v_cvt_pk_bf16_f32 v203, v206, v207
    v_xor_b32 v8, 0x10000, v8
    v_mfma_f32_16x16x32_bf16 v[196:199], a[212:215], a[180:183], v[196:199]
    s_bitcmp0_b32 s3, s7
    s_cselect_b32 s62, 0x2000, 0
    s_add_u32 s80, s80, s62
    v_mfma_f32_16x16x32_bf16 v[128:131], a[216:219], v[200:203], v[128:131]
    v_exp_f32 v192, v192
    v_mfma_f32_16x16x32_bf16 v[132:135], a[220:223], v[200:203], v[132:135]
    s_lshl2_add_u32 s81, s62, s81
    v_mfma_f32_16x16x32_bf16 v[136:139], a[224:227], v[200:203], v[136:139]
    v_exp_f32 v193, v193
    v_mfma_f32_16x16x32_bf16 v[140:143], a[228:231], v[200:203], v[140:143]
    v_xor_b32 v9, 0x10000, v9
    v_mfma_f32_16x16x32_bf16 v[144:147], a[232:235], v[200:203], v[144:147]
    v_exp_f32 v194, v194
    v_mfma_f32_16x16x32_bf16 v[148:151], a[236:239], v[200:203], v[148:151]
    v_cvt_pk_bf16_f32 v192, v192, v193
    s_and_b32 s81, s81, 0x1ffff
    v_mfma_f32_16x16x32_bf16 v[152:155], a[240:243], v[200:203], v[152:155]
    v_exp_f32 v195, v195
    v_mfma_f32_16x16x32_bf16 v[156:159], a[244:247], v[200:203], v[156:159]
    s_add_u32 s7, s7, 1
    v_xor_b32 v10, 0x10000, v10
    v_mfma_f32_16x16x32_bf16 a[76:79], a[248:251], v[200:203], a[76:79]
    v_exp_f32 v196, v196
    s_cmp_lt_u32 s7, 15
    s_cbranch_scc1 Lattn_loop
    s_waitcnt vmcnt(0) lgkmcnt(0)
    s_barrier
    v_mfma_f32_16x16x32_bf16 v[200:203], a[0:3], a[104:107], v[208:211]
    ds_read_b64_tr_b16 a[32:33], v11 offset:32768
    v_cvt_pk_bf16_f32 v193, v194, v195
    v_mfma_f32_16x16x32_bf16 v[200:203], a[4:7], a[108:111], v[200:203]
    v_exp_f32 v197, v197
    v_mfma_f32_16x16x32_bf16 v[200:203], a[8:11], a[112:115], v[200:203]
    ds_read_b64_tr_b16 a[34:35], v11 offset:36864
    s_lshl3_add_u32 s61, s48, s49
    s_lshl_b32 s7, s61, 4
    v_mfma_f32_16x16x32_bf16 v[200:203], a[12:15], a[116:119], v[200:203]
    buffer_load_dwordx4 v[248:251], off, s[36:39], s7 sc1
    v_exp_f32 v198, v198
    v_mfma_f32_16x16x32_bf16 v[204:207], a[16:19], a[104:107], v[208:211]
    ds_read_b64_tr_b16 a[36:37], v12 offset:32768
    v_cvt_pk_bf16_f32 v194, v196, v197
    v_mfma_f32_16x16x32_bf16 v[204:207], a[20:23], a[108:111], v[204:207]
    v_exp_f32 v199, v199
    v_mfma_f32_16x16x32_bf16 v[204:207], a[24:27], a[112:115], v[204:207]
    ds_read_b64_tr_b16 a[38:39], v12 offset:36864
    v_cvt_pk_bf16_f32 v195, v198, v199
    v_mfma_f32_16x16x32_bf16 v[204:207], a[28:31], a[116:119], v[204:207]
    ds_read_b64_tr_b16 a[40:41], v13 offset:32768
    ds_read_b64_tr_b16 a[42:43], v13 offset:36864
    v_mfma_f32_16x16x32_bf16 v[160:163], a[216:219], v[192:195], v[160:163]
    v_exp_f32 v200, v200
    v_mfma_f32_16x16x32_bf16 v[164:167], a[220:223], v[192:195], v[164:167]
    ds_read_b64_tr_b16 a[44:45], v14 offset:32768
    s_add_u32 s56, s93, 0
    s_lshl_b32 s56, s56, 17
    s_add_u32 m0, s95, 0
    v_mfma_f32_16x16x32_bf16 v[168:171], a[224:227], v[192:195], v[168:171]
    buffer_load_dwordx4 v228, s[28:31], s56 offen offset:0 lds
    v_exp_f32 v201, v201
    v_mov_b32 v31, 0
    v_mfma_f32_16x16x32_bf16 v[172:175], a[228:231], v[192:195], v[172:175]
    ds_read_b64_tr_b16 a[46:47], v14 offset:36864
    ds_read_b64_tr_b16 a[48:49], v15 offset:32768
    v_mfma_f32_16x16x32_bf16 v[176:179], a[232:235], v[192:195], v[176:179]
    buffer_load_dwordx4 v229, s[28:31], s56 offen offset:1024 lds
    buffer_load_dwordx4 v230, s[28:31], s56 offen offset:2048 lds
    v_exp_f32 v202, v202
    v_mfma_f32_16x16x32_bf16 v[180:183], a[236:239], v[192:195], v[180:183]
    ds_read_b64_tr_b16 a[50:51], v15 offset:36864
    v_cvt_pk_bf16_f32 v200, v200, v201
    v_mfma_f32_16x16x32_bf16 v[184:187], a[240:243], v[192:195], v[184:187]
    buffer_load_dwordx4 v231, s[28:31], s56 offen offset:3072 lds
    v_exp_f32 v203, v203
    v_mfma_f32_16x16x32_bf16 v[188:191], a[244:247], v[192:195], v[188:191]
    ds_read_b64_tr_b16 a[52:53], v16 offset:32768
    ds_read_b64_tr_b16 a[54:55], v16 offset:36864
    v_mfma_f32_16x16x32_bf16 a[80:83], a[248:251], v[192:195], a[80:83]
    v_exp_f32 v204, v204
    s_add_u32 s56, s93, 1
    v_mfma_f32_16x16x32_bf16 v[192:195], a[0:3], a[120:123], v[212:215]
    ds_read_b64_tr_b16 a[56:57], v17 offset:32768
    v_cvt_pk_bf16_f32 v201, v202, v203
    v_mfma_f32_16x16x32_bf16 v[192:195], a[4:7], a[124:127], v[192:195]
    v_exp_f32 v205, v205
    v_mfma_f32_16x16x32_bf16 v[192:195], a[8:11], a[128:131], v[192:195]
    ds_read_b64_tr_b16 a[58:59], v17 offset:36864
    ds_read_b64_tr_b16 a[60:61], v18 offset:32768
    v_mfma_f32_16x16x32_bf16 v[192:195], a[12:15], a[132:135], v[192:195]
    ds_read_b64_tr_b16 a[62:63], v18 offset:36864
    v_exp_f32 v206, v206
    v_mfma_f32_16x16x32_bf16 v[196:199], a[16:19], a[120:123], v[212:215]
    v_cvt_pk_bf16_f32 v202, v204, v205
    s_lshl_b32 s56, s56, 17
    v_mfma_f32_16x16x32_bf16 v[196:199], a[20:23], a[124:127], v[196:199]
    v_exp_f32 v207, v207
    v_mfma_f32_16x16x32_bf16 v[196:199], a[24:27], a[128:131], v[196:199]
    v_cvt_pk_bf16_f32 v203, v206, v207
    s_add_u32 m0, s95, 16384
    v_mfma_f32_16x16x32_bf16 v[196:199], a[28:31], a[132:135], v[196:199]
    buffer_load_dwordx4 v228, s[28:31], s56 offen offset:0 lds
    s_waitcnt lgkmcnt(14)
    v_mfma_f32_16x16x32_bf16 v[32:35], a[32:35], v[200:203], v[32:35]
    v_exp_f32 v192, v192
    s_waitcnt lgkmcnt(12)
    v_mfma_f32_16x16x32_bf16 v[36:39], a[36:39], v[200:203], v[36:39]
    buffer_load_dwordx4 v229, s[28:31], s56 offen offset:1024 lds
    s_waitcnt lgkmcnt(10)
    v_mfma_f32_16x16x32_bf16 v[40:43], a[40:43], v[200:203], v[40:43]
    v_exp_f32 v193, v193
    s_waitcnt lgkmcnt(8)
    v_mfma_f32_16x16x32_bf16 v[44:47], a[44:47], v[200:203], v[44:47]
    buffer_load_dwordx4 v230, s[28:31], s56 offen offset:2048 lds
    buffer_load_dwordx4 v231, s[28:31], s56 offen offset:3072 lds
    s_waitcnt lgkmcnt(6)
    v_mfma_f32_16x16x32_bf16 v[48:51], a[48:51], v[200:203], v[48:51]
    v_exp_f32 v194, v194
    s_waitcnt lgkmcnt(4)
    v_mfma_f32_16x16x32_bf16 v[52:55], a[52:55], v[200:203], v[52:55]
    v_cvt_pk_bf16_f32 v192, v192, v193
    s_add_u32 s56, s93, 2
    s_waitcnt lgkmcnt(2)
    v_mfma_f32_16x16x32_bf16 v[56:59], a[56:59], v[200:203], v[56:59]
    v_exp_f32 v195, v195
    s_waitcnt lgkmcnt(0)
    v_mfma_f32_16x16x32_bf16 v[60:63], a[60:63], v[200:203], v[60:63]
    s_lshl_b32 s56, s56, 17
    s_add_u32 m0, s95, 32768
    v_mfma_f32_16x16x32_bf16 a[64:67], a[248:251], v[200:203], a[64:67]
    v_exp_f32 v196, v196
    v_mfma_f32_16x16x32_bf16 v[200:203], a[0:3], a[136:139], v[216:219]
    v_cvt_pk_bf16_f32 v193, v194, v195
    v_mfma_f32_16x16x32_bf16 v[200:203], a[4:7], a[140:143], v[200:203]
    v_exp_f32 v197, v197
    v_mfma_f32_16x16x32_bf16 v[200:203], a[8:11], a[144:147], v[200:203]
    buffer_load_dwordx4 v228, s[28:31], s56 offen offset:0 lds
    buffer_load_dwordx4 v229, s[28:31], s56 offen offset:1024 lds
    buffer_load_dwordx4 v230, s[28:31], s56 offen offset:2048 lds
    buffer_load_dwordx4 v231, s[28:31], s56 offen offset:3072 lds
    v_mfma_f32_16x16x32_bf16 v[200:203], a[12:15], a[148:151], v[200:203]
    v_exp_f32 v198, v198
    v_mfma_f32_16x16x32_bf16 v[204:207], a[16:19], a[136:139], v[216:219]
    v_cvt_pk_bf16_f32 v194, v196, v197
    v_accvgpr_read_b32 v26, a64
    v_mfma_f32_16x16x32_bf16 v[204:207], a[20:23], a[140:143], v[204:207]
    v_exp_f32 v199, v199
    v_mfma_f32_16x16x32_bf16 v[204:207], a[24:27], a[144:147], v[204:207]
    v_cvt_pk_bf16_f32 v195, v198, v199
    s_mov_b32 s92, 0
    v_mfma_f32_16x16x32_bf16 v[204:207], a[28:31], a[148:151], v[204:207]
    v_max_u32 v31, v31, v26
    v_mfma_f32_16x16x32_bf16 v[64:67], a[32:35], v[192:195], v[64:67]
    v_exp_f32 v200, v200
    v_mfma_f32_16x16x32_bf16 v[68:71], a[36:39], v[192:195], v[68:71]
    v_rcp_f32 v26, v26
    s_nop 0
    v_mul_f32 v32, v26, v32
    v_mul_f32 v33, v26, v33
    v_mfma_f32_16x16x32_bf16 v[72:75], a[40:43], v[192:195], v[72:75]
    v_exp_f32 v201, v201
    v_mfma_f32_16x16x32_bf16 v[76:79], a[44:47], v[192:195], v[76:79]
    v_mul_f32 v34, v26, v34
    v_mul_f32 v35, v26, v35
    v_mul_f32 v36, v26, v36
    v_mul_f32 v37, v26, v37
    v_mul_f32 v38, v26, v38
    v_mfma_f32_16x16x32_bf16 v[80:83], a[48:51], v[192:195], v[80:83]
    v_exp_f32 v202, v202
    v_mfma_f32_16x16x32_bf16 v[84:87], a[52:55], v[192:195], v[84:87]
    v_cvt_pk_bf16_f32 v200, v200, v201
    v_mul_f32 v39, v26, v39
    v_cvt_pk_bf16_f32 v32, v32, v33
    v_cvt_pk_bf16_f32 v33, v34, v35
    v_cvt_pk_bf16_f32 v34, v36, v37
    v_cvt_pk_bf16_f32 v35, v38, v39
    v_mfma_f32_16x16x32_bf16 v[88:91], a[56:59], v[192:195], v[88:91]
    v_exp_f32 v203, v203
    v_mfma_f32_16x16x32_bf16 v[92:95], a[60:63], v[192:195], v[92:95]
    buffer_store_dwordx4 v[32:35], v24, s[24:27], s92 offen offset:0 sc1
    ds_write_b128 v25, v[32:35] offset:0
    v_mul_f32 v40, v26, v40
    v_mul_f32 v41, v26, v41
    v_mfma_f32_16x16x32_bf16 a[68:71], a[248:251], v[192:195], a[68:71]
    v_exp_f32 v204, v204
    v_mfma_f32_16x16x32_bf16 v[192:195], a[0:3], a[152:155], v[220:223]
    v_cvt_pk_bf16_f32 v201, v202, v203
    v_mul_f32 v42, v26, v42
    v_mul_f32 v43, v26, v43
    v_mul_f32 v44, v26, v44
    v_mul_f32 v45, v26, v45
    v_mul_f32 v46, v26, v46
    v_mfma_f32_16x16x32_bf16 v[192:195], a[4:7], a[156:159], v[192:195]
    v_exp_f32 v205, v205
    v_mfma_f32_16x16x32_bf16 v[192:195], a[8:11], a[160:163], v[192:195]
    v_mul_f32 v47, v26, v47
    v_cvt_pk_bf16_f32 v40, v40, v41
    v_cvt_pk_bf16_f32 v41, v42, v43
    v_cvt_pk_bf16_f32 v42, v44, v45
    v_cvt_pk_bf16_f32 v43, v46, v47
    v_mfma_f32_16x16x32_bf16 v[192:195], a[12:15], a[164:167], v[192:195]
    buffer_store_dwordx4 v[40:43], v24, s[24:27], s92 offen offset:1024 sc1
    v_exp_f32 v206, v206
    v_mfma_f32_16x16x32_bf16 v[196:199], a[16:19], a[152:155], v[220:223]
    ds_write_b128 v25, v[40:43] offset:1024
    v_cvt_pk_bf16_f32 v202, v204, v205
    v_mul_f32 v48, v26, v48
    v_mul_f32 v49, v26, v49
    v_mul_f32 v50, v26, v50
    v_mfma_f32_16x16x32_bf16 v[196:199], a[20:23], a[156:159], v[196:199]
    v_exp_f32 v207, v207
    v_mfma_f32_16x16x32_bf16 v[196:199], a[24:27], a[160:163], v[196:199]
    v_cvt_pk_bf16_f32 v203, v206, v207
    v_mul_f32 v51, v26, v51
    v_mul_f32 v52, v26, v52
    v_mfma_f32_16x16x32_bf16 v[196:199], a[28:31], a[164:167], v[196:199]
    v_mul_f32 v53, v26, v53
    v_mul_f32 v54, v26, v54
    v_mul_f32 v55, v26, v55
    v_cvt_pk_bf16_f32 v48, v48, v49
    v_cvt_pk_bf16_f32 v49, v50, v51
    v_mfma_f32_16x16x32_bf16 v[96:99], a[32:35], v[200:203], v[96:99]
    v_exp_f32 v192, v192
    v_mfma_f32_16x16x32_bf16 v[100:103], a[36:39], v[200:203], v[100:103]
    v_cvt_pk_bf16_f32 v50, v52, v53
    v_cvt_pk_bf16_f32 v51, v54, v55
    v_mfma_f32_16x16x32_bf16 v[104:107], a[40:43], v[200:203], v[104:107]
    buffer_store_dwordx4 v[48:51], v24, s[24:27], s92 offen offset:2048 sc1
    ds_write_b128 v25, v[48:51] offset:20480
    v_exp_f32 v193, v193
    v_mul_f32 v56, v26, v56
    v_mfma_f32_16x16x32_bf16 v[108:111], a[44:47], v[200:203], v[108:111]
    v_mul_f32 v57, v26, v57
    v_mul_f32 v58, v26, v58
    v_mul_f32 v59, v26, v59
    v_mul_f32 v60, v26, v60
    v_mul_f32 v61, v26, v61
    v_mul_f32 v62, v26, v62
    v_mul_f32 v63, v26, v63
    v_cvt_pk_bf16_f32 v56, v56, v57
    v_cvt_pk_bf16_f32 v57, v58, v59
    v_cvt_pk_bf16_f32 v58, v60, v61
    v_cvt_pk_bf16_f32 v59, v62, v63
    buffer_store_dwordx4 v[56:59], v24, s[24:27], s92 offen offset:3072 sc1
    ds_write_b128 v25, v[56:59] offset:21504
    v_mfma_f32_16x16x32_bf16 v[112:115], a[48:51], v[200:203], v[112:115]
    v_exp_f32 v194, v194
    v_mfma_f32_16x16x32_bf16 v[116:119], a[52:55], v[200:203], v[116:119]
    v_cvt_pk_bf16_f32 v192, v192, v193
    v_accvgpr_read_b32 v28, a68
    v_mfma_f32_16x16x32_bf16 v[120:123], a[56:59], v[200:203], v[120:123]
    v_exp_f32 v195, v195
    v_mfma_f32_16x16x32_bf16 v[124:127], a[60:63], v[200:203], v[124:127]
    s_mov_b32 s92, 131072
    v_max_u32 v31, v31, v28
    v_rcp_f32 v28, v28
    v_mfma_f32_16x16x32_bf16 a[72:75], a[248:251], v[200:203], a[72:75]
    v_exp_f32 v196, v196
    v_mfma_f32_16x16x32_bf16 v[200:203], a[0:3], a[168:171], v[224:227]
    v_cvt_pk_bf16_f32 v193, v194, v195
    v_mul_f32 v64, v28, v64
    v_mul_f32 v65, v28, v65
    v_mul_f32 v66, v28, v66
    v_mul_f32 v67, v28, v67
    v_mul_f32 v68, v28, v68
    v_mfma_f32_16x16x32_bf16 v[200:203], a[4:7], a[172:175], v[200:203]
    v_exp_f32 v197, v197
    v_mfma_f32_16x16x32_bf16 v[200:203], a[8:11], a[176:179], v[200:203]
    v_mul_f32 v69, v28, v69
    v_mul_f32 v70, v28, v70
    v_mul_f32 v71, v28, v71
    v_cvt_pk_bf16_f32 v64, v64, v65
    v_cvt_pk_bf16_f32 v65, v66, v67
    v_mfma_f32_16x16x32_bf16 v[200:203], a[12:15], a[180:183], v[200:203]
    v_exp_f32 v198, v198
    v_mfma_f32_16x16x32_bf16 v[204:207], a[16:19], a[168:171], v[224:227]
    v_cvt_pk_bf16_f32 v194, v196, v197
    v_cvt_pk_bf16_f32 v66, v68, v69
    v_cvt_pk_bf16_f32 v67, v70, v71
    buffer_store_dwordx4 v[64:67], v24, s[24:27], s92 offen offset:0 sc1
    v_mfma_f32_16x16x32_bf16 v[204:207], a[20:23], a[172:175], v[204:207]
    ds_write_b128 v25, v[64:67] offset:2048
    v_exp_f32 v199, v199
    v_mul_f32 v72, v28, v72
    v_mul_f32 v73, v28, v73
    v_mfma_f32_16x16x32_bf16 v[204:207], a[24:27], a[176:179], v[204:207]
    v_cvt_pk_bf16_f32 v195, v198, v199
    v_mul_f32 v74, v28, v74
    v_mul_f32 v75, v28, v75
    v_mfma_f32_16x16x32_bf16 v[204:207], a[28:31], a[180:183], v[204:207]
    v_mul_f32 v76, v28, v76
    v_mul_f32 v77, v28, v77
    v_mul_f32 v78, v28, v78
    v_mul_f32 v79, v28, v79
    v_cvt_pk_bf16_f32 v72, v72, v73
    v_mfma_f32_16x16x32_bf16 v[128:131], a[32:35], v[192:195], v[128:131]
    v_exp_f32 v200, v200
    v_mfma_f32_16x16x32_bf16 v[132:135], a[36:39], v[192:195], v[132:135]
    v_cvt_pk_bf16_f32 v73, v74, v75
    v_cvt_pk_bf16_f32 v74, v76, v77
    v_cvt_pk_bf16_f32 v75, v78, v79
    v_mfma_f32_16x16x32_bf16 v[136:139], a[40:43], v[192:195], v[136:139]
    buffer_store_dwordx4 v[72:75], v24, s[24:27], s92 offen offset:1024 sc1
    ds_write_b128 v25, v[72:75] offset:3072
    v_exp_f32 v201, v201
    v_mul_f32 v80, v28, v80
    v_mfma_f32_16x16x32_bf16 v[140:143], a[44:47], v[192:195], v[140:143]
    v_mul_f32 v81, v28, v81
    v_mul_f32 v82, v28, v82
    v_mul_f32 v83, v28, v83
    v_mul_f32 v84, v28, v84
    v_mul_f32 v85, v28, v85
    v_mfma_f32_16x16x32_bf16 v[144:147], a[48:51], v[192:195], v[144:147]
    v_exp_f32 v202, v202
    v_mfma_f32_16x16x32_bf16 v[148:151], a[52:55], v[192:195], v[148:151]
    v_cvt_pk_bf16_f32 v200, v200, v201
    v_mul_f32 v86, v28, v86
    v_mul_f32 v87, v28, v87
    v_cvt_pk_bf16_f32 v80, v80, v81
    v_cvt_pk_bf16_f32 v81, v82, v83
    v_cvt_pk_bf16_f32 v82, v84, v85
    v_mfma_f32_16x16x32_bf16 v[152:155], a[56:59], v[192:195], v[152:155]
    v_exp_f32 v203, v203
    v_mfma_f32_16x16x32_bf16 v[156:159], a[60:63], v[192:195], v[156:159]
    v_cvt_pk_bf16_f32 v83, v86, v87
    buffer_store_dwordx4 v[80:83], v24, s[24:27], s92 offen offset:2048 sc1
    ds_write_b128 v25, v[80:83] offset:22528
    v_mul_f32 v88, v28, v88
    v_mul_f32 v89, v28, v89
    v_mul_f32 v90, v28, v90
    v_mul_f32 v91, v28, v91
    v_mul_f32 v92, v28, v92
    v_mul_f32 v93, v28, v93
    v_mul_f32 v94, v28, v94
    v_mul_f32 v95, v28, v95
    v_cvt_pk_bf16_f32 v88, v88, v89
    v_cvt_pk_bf16_f32 v89, v90, v91
    v_cvt_pk_bf16_f32 v90, v92, v93
    v_mfma_f32_16x16x32_bf16 a[76:79], a[248:251], v[192:195], a[76:79]
    v_exp_f32 v204, v204
    v_cvt_pk_bf16_f32 v91, v94, v95
    buffer_store_dwordx4 v[88:91], v24, s[24:27], s92 offen offset:3072 sc1
    ds_write_b128 v25, v[88:91] offset:23552
    v_cvt_pk_bf16_f32 v201, v202, v203
    v_accvgpr_read_b32 v26, a72
    s_mov_b32 s92, 262144
    v_max_u32 v31, v31, v26
    v_rcp_f32 v26, v26
    v_exp_f32 v205, v205
    v_pk_mul_f32 v[96:97], v[96:97], v[26:27] op_sel_hi:[1,0]
    v_pk_mul_f32 v[98:99], v[98:99], v[26:27] op_sel_hi:[1,0]
    v_pk_mul_f32 v[100:101], v[100:101], v[26:27] op_sel_hi:[1,0]
    v_pk_mul_f32 v[102:103], v[102:103], v[26:27] op_sel_hi:[1,0]
    v_exp_f32 v206, v206
    v_cvt_pk_bf16_f32 v96, v96, v97
    v_cvt_pk_bf16_f32 v97, v98, v99
    v_cvt_pk_bf16_f32 v98, v100, v101
    v_cvt_pk_bf16_f32 v99, v102, v103
    v_cvt_pk_bf16_f32 v202, v204, v205
    buffer_store_dwordx4 v[96:99], v24, s[24:27], s92 offen offset:0 sc1
    ds_write_b128 v25, v[96:99] offset:4096
    v_pk_mul_f32 v[104:105], v[104:105], v[26:27] op_sel_hi:[1,0]
    v_pk_mul_f32 v[106:107], v[106:107], v[26:27] op_sel_hi:[1,0]
    v_exp_f32 v207, v207
    v_pk_mul_f32 v[108:109], v[108:109], v[26:27] op_sel_hi:[1,0]
    v_pk_mul_f32 v[110:111], v[110:111], v[26:27] op_sel_hi:[1,0]
    v_cvt_pk_bf16_f32 v104, v104, v105
    v_cvt_pk_bf16_f32 v105, v106, v107
    v_cvt_pk_bf16_f32 v203, v206, v207
    v_cvt_pk_bf16_f32 v106, v108, v109
    v_cvt_pk_bf16_f32 v107, v110, v111
    buffer_store_dwordx4 v[104:107], v24, s[24:27], s92 offen offset:1024 sc1
    ds_write_b128 v25, v[104:107] offset:5120
    v_pk_mul_f32 v[112:113], v[112:113], v[26:27] op_sel_hi:[1,0]
    v_pk_mul_f32 v[114:115], v[114:115], v[26:27] op_sel_hi:[1,0]
    v_pk_mul_f32 v[116:117], v[116:117], v[26:27] op_sel_hi:[1,0]
    v_pk_mul_f32 v[118:119], v[118:119], v[26:27] op_sel_hi:[1,0]
    v_cvt_pk_bf16_f32 v112, v112, v113
    v_cvt_pk_bf16_f32 v113, v114, v115
    v_cvt_pk_bf16_f32 v114, v116, v117
    v_cvt_pk_bf16_f32 v115, v118, v119
    buffer_store_dwordx4 v[112:115], v24, s[24:27], s92 offen offset:2048 sc1
    ds_write_b128 v25, v[112:115] offset:24576
    v_pk_mul_f32 v[120:121], v[120:121], v[26:27] op_sel_hi:[1,0]
    v_pk_mul_f32 v[122:123], v[122:123], v[26:27] op_sel_hi:[1,0]
    v_pk_mul_f32 v[124:125], v[124:125], v[26:27] op_sel_hi:[1,0]
    v_pk_mul_f32 v[126:127], v[126:127], v[26:27] op_sel_hi:[1,0]
    v_cvt_pk_bf16_f32 v120, v120, v121
    v_cvt_pk_bf16_f32 v121, v122, v123
    v_cvt_pk_bf16_f32 v122, v124, v125
    v_cvt_pk_bf16_f32 v123, v126, v127
    buffer_store_dwordx4 v[120:123], v24, s[24:27], s92 offen offset:3072 sc1
    ds_write_b128 v25, v[120:123] offset:25600
    v_mfma_f32_16x16x32_bf16 v[160:163], a[32:35], v[200:203], v[160:163]
    v_accvgpr_read_b32 v28, a76
    s_mov_b32 s92, 393216
    v_mfma_f32_16x16x32_bf16 v[164:167], a[36:39], v[200:203], v[164:167]
    v_max_u32 v31, v31, v28
    v_rcp_f32 v28, v28
    s_nop 0
    v_mul_f32 v128, v28, v128
    v_mul_f32 v129, v28, v129
    v_mul_f32 v130, v28, v130
    v_mul_f32 v131, v28, v131
    v_mul_f32 v132, v28, v132
    v_mul_f32 v133, v28, v133
    v_mfma_f32_16x16x32_bf16 v[168:171], a[40:43], v[200:203], v[168:171]
    v_mul_f32 v134, v28, v134
    v_mul_f32 v135, v28, v135
    v_cvt_pk_bf16_f32 v128, v128, v129
    v_cvt_pk_bf16_f32 v129, v130, v131
    v_cvt_pk_bf16_f32 v130, v132, v133
    v_cvt_pk_bf16_f32 v131, v134, v135
    buffer_store_dwordx4 v[128:131], v24, s[24:27], s92 offen offset:0 sc1
    v_mfma_f32_16x16x32_bf16 v[172:175], a[44:47], v[200:203], v[172:175]
    ds_write_b128 v25, v[128:131] offset:6144
    v_mul_f32 v136, v28, v136
    v_mul_f32 v137, v28, v137
    v_mul_f32 v138, v28, v138
    v_mul_f32 v139, v28, v139
    v_mul_f32 v140, v28, v140
    v_mfma_f32_16x16x32_bf16 v[176:179], a[48:51], v[200:203], v[176:179]
    v_mul_f32 v141, v28, v141
    v_mul_f32 v142, v28, v142
    v_mul_f32 v143, v28, v143
    v_cvt_pk_bf16_f32 v136, v136, v137
    v_cvt_pk_bf16_f32 v137, v138, v139
    v_cvt_pk_bf16_f32 v138, v140, v141
    v_cvt_pk_bf16_f32 v139, v142, v143
    v_mfma_f32_16x16x32_bf16 v[180:183], a[52:55], v[200:203], v[180:183]
    buffer_store_dwordx4 v[136:139], v24, s[24:27], s92 offen offset:1024 sc1
    ds_write_b128 v25, v[136:139] offset:7168
    v_mul_f32 v144, v28, v144
    v_mul_f32 v145, v28, v145
    v_mul_f32 v146, v28, v146
    v_mul_f32 v147, v28, v147
    v_mul_f32 v148, v28, v148
    v_mfma_f32_16x16x32_bf16 v[184:187], a[56:59], v[200:203], v[184:187]
    v_mul_f32 v149, v28, v149
    v_mul_f32 v150, v28, v150
    v_mul_f32 v151, v28, v151
    v_cvt_pk_bf16_f32 v144, v144, v145
    v_cvt_pk_bf16_f32 v145, v146, v147
    v_cvt_pk_bf16_f32 v146, v148, v149
    v_mfma_f32_16x16x32_bf16 v[188:191], a[60:63], v[200:203], v[188:191]
    v_cvt_pk_bf16_f32 v147, v150, v151
    buffer_store_dwordx4 v[144:147], v24, s[24:27], s92 offen offset:2048 sc1
    ds_write_b128 v25, v[144:147] offset:26624
    v_mul_f32 v152, v28, v152
    v_mul_f32 v153, v28, v153
    v_mul_f32 v154, v28, v154
    v_mul_f32 v155, v28, v155
    v_mfma_f32_16x16x32_bf16 a[80:83], a[248:251], v[200:203], a[80:83]
    v_mul_f32 v156, v28, v156
    v_mul_f32 v157, v28, v157
    v_mul_f32 v158, v28, v158
    v_mul_f32 v159, v28, v159
    v_cvt_pk_bf16_f32 v152, v152, v153
    v_cvt_pk_bf16_f32 v153, v154, v155
    v_cvt_pk_bf16_f32 v154, v156, v157
    v_cvt_pk_bf16_f32 v155, v158, v159
    buffer_store_dwordx4 v[152:155], v24, s[24:27], s92 offen offset:3072 sc1
    ds_write_b128 v25, v[152:155] offset:27648
    v_accvgpr_read_b32 v26, a80
    s_mov_b32 s92, 524288
    v_max_u32 v31, v31, v26
    v_rcp_f32 v26, v26
    s_nop 0
    v_pk_mul_f32 v[160:161], v[160:161], v[26:27] op_sel_hi:[1,0]
    v_pk_mul_f32 v[162:163], v[162:163], v[26:27] op_sel_hi:[1,0]
    v_pk_mul_f32 v[164:165], v[164:165], v[26:27] op_sel_hi:[1,0]
    v_pk_mul_f32 v[166:167], v[166:167], v[26:27] op_sel_hi:[1,0]
    v_cvt_pk_bf16_f32 v160, v160, v161
    v_cvt_pk_bf16_f32 v161, v162, v163
    v_cvt_pk_bf16_f32 v162, v164, v165
    v_cvt_pk_bf16_f32 v163, v166, v167
    buffer_store_dwordx4 v[160:163], v24, s[24:27], s92 offen offset:0 sc1
    ds_write_b128 v25, v[160:163] offset:8192
    v_pk_mul_f32 v[168:169], v[168:169], v[26:27] op_sel_hi:[1,0]
    v_pk_mul_f32 v[170:171], v[170:171], v[26:27] op_sel_hi:[1,0]
    v_pk_mul_f32 v[172:173], v[172:173], v[26:27] op_sel_hi:[1,0]
    v_pk_mul_f32 v[174:175], v[174:175], v[26:27] op_sel_hi:[1,0]
    v_cvt_pk_bf16_f32 v168, v168, v169
    v_cvt_pk_bf16_f32 v169, v170, v171
    v_cvt_pk_bf16_f32 v170, v172, v173
    v_cvt_pk_bf16_f32 v171, v174, v175
    buffer_store_dwordx4 v[168:171], v24, s[24:27], s92 offen offset:1024 sc1
    ds_write_b128 v25, v[168:171] offset:9216
    v_pk_mul_f32 v[176:177], v[176:177], v[26:27] op_sel_hi:[1,0]
    v_pk_mul_f32 v[178:179], v[178:179], v[26:27] op_sel_hi:[1,0]
    v_pk_mul_f32 v[180:181], v[180:181], v[26:27] op_sel_hi:[1,0]
    v_pk_mul_f32 v[182:183], v[182:183], v[26:27] op_sel_hi:[1,0]
    v_cvt_pk_bf16_f32 v176, v176, v177
    v_cvt_pk_bf16_f32 v177, v178, v179
    v_cvt_pk_bf16_f32 v178, v180, v181
    v_cvt_pk_bf16_f32 v179, v182, v183
    buffer_store_dwordx4 v[176:179], v24, s[24:27], s92 offen offset:2048 sc1
    ds_write_b128 v25, v[176:179] offset:28672
    v_pk_mul_f32 v[184:185], v[184:185], v[26:27] op_sel_hi:[1,0]
    v_pk_mul_f32 v[186:187], v[186:187], v[26:27] op_sel_hi:[1,0]
    v_pk_mul_f32 v[188:189], v[188:189], v[26:27] op_sel_hi:[1,0]
    v_pk_mul_f32 v[190:191], v[190:191], v[26:27] op_sel_hi:[1,0]
    v_cvt_pk_bf16_f32 v184, v184, v185
    v_cvt_pk_bf16_f32 v185, v186, v187
    v_cvt_pk_bf16_f32 v186, v188, v189
    v_cvt_pk_bf16_f32 v187, v190, v191
    buffer_store_dwordx4 v[184:187], v24, s[24:27], s92 offen offset:3072 sc1
    ds_write_b128 v25, v[184:187] offset:29696
    v_cmp_le_u32 vcc, 0x4b800000, v31
    s_lshl_b32 s62, s4, 2
    s_add_u32 s62, s62, 162816
    v_mov_b32 v27, s62
    s_cmp_lg_u64 vcc, 0
    s_cselect_b32 s61, 1, 0
    v_mov_b32 v26, s61
    ds_write_b32 v27, v26
    s_waitcnt vmcnt(20)
    v_mov_b32 v27, 162816
    s_waitcnt lgkmcnt(0)
    s_barrier
    ds_read_b128 v[28:31], v27
    ds_read_b128 a[32:35], v241 offset:0
    ds_read_b128 a[36:39], v241 offset:1024
    ds_read_b64_tr_b16 a[0:1], v237 offset:0
    ds_read_b64_tr_b16 a[2:3], v237 offset:4096
    ds_read_b64_tr_b16 a[4:5], v237 offset:8192
    ds_read_b64_tr_b16 a[6:7], v237 offset:12288
    ds_read_b128 a[40:43], v241 offset:2048
    ds_read_b128 a[44:47], v241 offset:3072
    ds_read_b128 a[48:51], v241 offset:4096
    ds_read_b128 a[52:55], v241 offset:5120
    ds_read_b128 a[56:59], v241 offset:6144
    ds_read_b128 a[60:63], v241 offset:7168
    ds_read_b128 a[64:67], v241 offset:8192
    ds_read_b128 a[68:71], v241 offset:9216
    s_waitcnt lgkmcnt(14)
    v_or3_b32 v28, v28, v29, v30
    v_or_b32 v28, v28, v31
    s_nop 0
    v_readfirstlane_b32 s61, v28
    s_nop 1
    s_andn2_b32 s61, s61, s94
    s_cmp_lg_u32 s61, 0
    s_cbranch_scc1 Lfallback
Lp2_start:
    s_waitcnt lgkmcnt(10)
    v_mfma_f32_16x16x32_bf16 v[32:35], a[0:3], a[32:35], 0
    ds_read_b64_tr_b16 a[8:9], v238 offset:0
    v_and_b32 v26, v248, v249
    s_waitcnt lgkmcnt(9)
    v_mfma_f32_16x16x32_bf16 v[32:35], a[4:7], a[36:39], v[32:35]
    ds_read_b64_tr_b16 a[10:11], v238 offset:4096
    s_waitcnt lgkmcnt(9)
    v_mfma_f32_16x16x32_bf16 v[48:51], a[0:3], a[40:43], 0
    ds_read_b64_tr_b16 a[12:13], v238 offset:8192
    ds_read_b64_tr_b16 a[14:15], v238 offset:12288
    s_waitcnt lgkmcnt(10)
    v_mfma_f32_16x16x32_bf16 v[48:51], a[4:7], a[44:47], v[48:51]
    ds_read_b64_tr_b16 a[16:17], v239 offset:0
    v_and_b32 v27, v250, v251
    s_waitcnt lgkmcnt(10)
    v_mfma_f32_16x16x32_bf16 v[64:67], a[0:3], a[48:51], 0
    ds_read_b64_tr_b16 a[18:19], v239 offset:4096
    ds_read_b64_tr_b16 a[20:21], v239 offset:8192
    s_waitcnt lgkmcnt(11)
    v_mfma_f32_16x16x32_bf16 v[64:67], a[4:7], a[52:55], v[64:67]
    ds_read_b64_tr_b16 a[22:23], v239 offset:12288
    v_and_b32 v26, v26, v27
    s_waitcnt lgkmcnt(11)
    v_mfma_f32_16x16x32_bf16 v[80:83], a[0:3], a[56:59], 0
    ds_read_b64_tr_b16 a[24:25], v240 offset:0
    ds_read_b64_tr_b16 a[26:27], v240 offset:4096
    s_waitcnt lgkmcnt(12)
    v_mfma_f32_16x16x32_bf16 v[80:83], a[4:7], a[60:63], v[80:83]
    ds_read_b64_tr_b16 a[28:29], v240 offset:8192
    ds_read_b64_tr_b16 a[30:31], v240 offset:12288
    s_waitcnt lgkmcnt(13)
    v_mfma_f32_16x16x32_bf16 v[96:99], a[0:3], a[64:67], 0
    v_readfirstlane_b32 s63, v26
    v_mov_b32 v27, 1
    s_waitcnt lgkmcnt(12)
    v_mfma_f32_16x16x32_bf16 v[96:99], a[4:7], a[68:71], v[96:99]
    s_waitcnt lgkmcnt(0)
    s_barrier
    v_mfma_f32_16x16x32_bf16 v[36:39], a[8:11], a[32:35], 0
    ds_read_b128 a[72:75], v241 offset:20480
    s_add_u32 s56, s93, 3
    v_mfma_f32_16x16x32_bf16 v[36:39], a[12:15], a[36:39], v[36:39]
    ds_read_b64_tr_b16 a[0:1], v237 offset:16384
    v_mfma_f32_16x16x32_bf16 v[52:55], a[8:11], a[40:43], 0
    s_lshl_b32 s56, s56, 17
    v_mfma_f32_16x16x32_bf16 v[52:55], a[12:15], a[44:47], v[52:55]
    ds_read_b64_tr_b16 a[2:3], v237 offset:20480
    v_mfma_f32_16x16x32_bf16 v[68:71], a[8:11], a[48:51], 0
    ds_read_b128 a[76:79], v241 offset:21504
    s_add_u32 m0, s95, 49152
    v_mfma_f32_16x16x32_bf16 v[68:71], a[12:15], a[52:55], v[68:71]
    ds_read_b64_tr_b16 a[4:5], v237 offset:24576
    v_mfma_f32_16x16x32_bf16 v[84:87], a[8:11], a[56:59], 0
    buffer_load_dwordx4 v228, s[28:31], s56 offen offset:0 lds
    v_mfma_f32_16x16x32_bf16 v[84:87], a[12:15], a[60:63], v[84:87]
    ds_read_b128 a[80:83], v241 offset:22528
    v_mfma_f32_16x16x32_bf16 v[100:103], a[8:11], a[64:67], 0
    buffer_load_dwordx4 v229, s[28:31], s56 offen offset:1024 lds
    v_mfma_f32_16x16x32_bf16 v[100:103], a[12:15], a[68:71], v[100:103]
    ds_read_b64_tr_b16 a[6:7], v237 offset:28672
    ds_read_b128 a[84:87], v241 offset:23552
    v_mfma_f32_16x16x32_bf16 v[40:43], a[16:19], a[32:35], 0
    buffer_load_dwordx4 v230, s[28:31], s56 offen offset:2048 lds
    v_mfma_f32_16x16x32_bf16 v[40:43], a[20:23], a[36:39], v[40:43]
    ds_read_b64_tr_b16 a[8:9], v238 offset:16384
    ds_read_b128 a[88:91], v241 offset:24576
    v_mfma_f32_16x16x32_bf16 v[56:59], a[16:19], a[40:43], 0
    buffer_load_dwordx4 v231, s[28:31], s56 offen offset:3072 lds
    v_mfma_f32_16x16x32_bf16 v[56:59], a[20:23], a[44:47], v[56:59]
    ds_read_b64_tr_b16 a[10:11], v238 offset:20480
    s_mov_b32 s61, 0
    v_mfma_f32_16x16x32_bf16 v[72:75], a[16:19], a[48:51], 0
    ds_read_b128 a[92:95], v241 offset:25600
    s_lshr_b32 s62, s61, 2
    v_mfma_f32_16x16x32_bf16 v[72:75], a[20:23], a[52:55], v[72:75]
    s_cmp_ge_u32 s62, s52
    s_addc_u32 s62, s62, 0
    v_mfma_f32_16x16x32_bf16 v[88:91], a[16:19], a[56:59], 0
    ds_read_b128 a[96:99], v241 offset:26624
    s_add_u32 s61, s61, s52
    s_and_b32 s61, s61, 3
    v_mfma_f32_16x16x32_bf16 v[88:91], a[20:23], a[60:63], v[88:91]
    ds_read_b64_tr_b16 a[12:13], v238 offset:24576
    s_lshl2_add_u32 s61, s62, s61
    v_mfma_f32_16x16x32_bf16 v[104:107], a[16:19], a[64:67], 0
    ds_read_b64_tr_b16 a[14:15], v238 offset:28672
    s_lshl_b32 s55, s61, 11
    v_mfma_f32_16x16x32_bf16 v[104:107], a[20:23], a[68:71], v[104:107]
    ds_read_b128 a[100:103], v241 offset:27648
    s_lshl_b32 s56, s61, 17
    v_mfma_f32_16x16x32_bf16 v[44:47], a[24:27], a[32:35], 0
    ds_read_b128 a[104:107], v241 offset:28672
    v_mfma_f32_16x16x32_bf16 v[44:47], a[28:31], a[36:39], v[44:47]
    ds_read_b64_tr_b16 a[16:17], v239 offset:16384
    s_add_u32 m0, s95, 0
    v_mfma_f32_16x16x32_bf16 v[60:63], a[24:27], a[40:43], 0
    ds_read_b128 a[108:111], v241 offset:29696
    v_mfma_f32_16x16x32_bf16 v[60:63], a[28:31], a[44:47], v[60:63]
    buffer_load_dwordx4 v228, s[28:31], s56 offen offset:0 lds
    v_mfma_f32_16x16x32_bf16 v[76:79], a[24:27], a[48:51], 0
    ds_read_b64_tr_b16 a[18:19], v239 offset:20480
    v_mfma_f32_16x16x32_bf16 v[76:79], a[28:31], a[52:55], v[76:79]
    buffer_load_dwordx4 v229, s[28:31], s56 offen offset:1024 lds
    v_mfma_f32_16x16x32_bf16 v[92:95], a[24:27], a[56:59], 0
    ds_read_b64_tr_b16 a[20:21], v239 offset:24576
    v_mfma_f32_16x16x32_bf16 v[92:95], a[28:31], a[60:63], v[92:95]
    buffer_load_dwordx4 v230, s[28:31], s56 offen offset:2048 lds
    v_mfma_f32_16x16x32_bf16 v[108:111], a[24:27], a[64:67], 0
    ds_read_b64_tr_b16 a[22:23], v239 offset:28672
    v_mfma_f32_16x16x32_bf16 v[108:111], a[28:31], a[68:71], v[108:111]
    buffer_load_dwordx4 v231, s[28:31], s56 offen offset:3072 lds
    s_waitcnt lgkmcnt(15)
    v_mfma_f32_16x16x32_bf16 v[32:35], a[0:3], a[72:75], v[32:35]
    ds_read_b64_tr_b16 a[24:25], v240 offset:16384
    v_mfma_f32_16x16x32_bf16 v[32:35], a[4:7], a[76:79], v[32:35]
    v_mfma_f32_16x16x32_bf16 v[48:51], a[0:3], a[80:83], v[48:51]
    ds_read_b64_tr_b16 a[26:27], v240 offset:20480
    s_waitcnt lgkmcnt(15)
    v_mfma_f32_16x16x32_bf16 v[48:51], a[4:7], a[84:87], v[48:51]
    ds_read_b64_tr_b16 a[28:29], v240 offset:24576
    s_waitcnt lgkmcnt(15)
    v_mfma_f32_16x16x32_bf16 v[64:67], a[0:3], a[88:91], v[64:67]
    s_waitcnt lgkmcnt(13)
    v_mfma_f32_16x16x32_bf16 v[64:67], a[4:7], a[92:95], v[64:67]
    ds_read_b64_tr_b16 a[30:31], v240 offset:28672
    s_waitcnt lgkmcnt(13)
    v_mfma_f32_16x16x32_bf16 v[80:83], a[0:3], a[96:99], v[80:83]
    s_waitcnt lgkmcnt(10)
    v_mfma_f32_16x16x32_bf16 v[80:83], a[4:7], a[100:103], v[80:83]
    s_waitcnt lgkmcnt(9)
    v_mfma_f32_16x16x32_bf16 v[96:99], a[0:3], a[104:107], v[96:99]
    s_waitcnt lgkmcnt(7)
    v_mfma_f32_16x16x32_bf16 v[96:99], a[4:7], a[108:111], v[96:99]
    s_waitcnt vmcnt(8) lgkmcnt(0)
    s_barrier
    s_cmp_lg_u32 s63, 0x01010101
    s_cbranch_scc1 Lini_wait
Lini_ok:
    buffer_load_dword v28, v247, s[44:47], 0 offen sc1
    buffer_store_dword v27, v246, s[44:47], s83 offen sc1
    v_mfma_f32_16x16x32_bf16 v[36:39], a[8:11], a[72:75], v[36:39]
    ds_read_b128 a[32:35], v242 offset:0
    s_mov_b32 s61, 1
    v_mfma_f32_16x16x32_bf16 v[36:39], a[12:15], a[76:79], v[36:39]
    ds_read_b64_tr_b16 a[0:1], v237 offset:32768
    s_lshr_b32 s62, s61, 2
    v_mfma_f32_16x16x32_bf16 v[52:55], a[8:11], a[80:83], v[52:55]
    s_cmp_ge_u32 s62, s52
    s_addc_u32 s62, s62, 0
    v_mfma_f32_16x16x32_bf16 v[52:55], a[12:15], a[84:87], v[52:55]
    s_add_u32 s61, s61, s52
    s_and_b32 s61, s61, 3
    v_mfma_f32_16x16x32_bf16 v[68:71], a[8:11], a[88:91], v[68:71]
    ds_read_b64_tr_b16 a[2:3], v237 offset:36864
    s_lshl2_add_u32 s61, s62, s61
    v_mfma_f32_16x16x32_bf16 v[68:71], a[12:15], a[92:95], v[68:71]
    ds_read_b128 a[36:39], v242 offset:1024
    s_lshl_b32 s55, s61, 11
    v_mfma_f32_16x16x32_bf16 v[84:87], a[8:11], a[96:99], v[84:87]
    ds_read_b64_tr_b16 a[4:5], v237 offset:40960
    s_lshl_b32 s56, s61, 17
    v_mfma_f32_16x16x32_bf16 v[84:87], a[12:15], a[100:103], v[84:87]
    ds_read_b128 a[40:43], v242 offset:2048
    v_mfma_f32_16x16x32_bf16 v[100:103], a[8:11], a[104:107], v[100:103]
    ds_read_b64_tr_b16 a[6:7], v237 offset:45056
    s_add_u32 m0, s95, 16384
    v_mfma_f32_16x16x32_bf16 v[100:103], a[12:15], a[108:111], v[100:103]
    ds_read_b128 a[44:47], v242 offset:3072
    v_mfma_f32_16x16x32_bf16 v[40:43], a[16:19], a[72:75], v[40:43]
    ds_read_b64_tr_b16 a[8:9], v238 offset:32768
    v_mfma_f32_16x16x32_bf16 v[40:43], a[20:23], a[76:79], v[40:43]
    buffer_load_dwordx4 v228, s[28:31], s56 offen offset:0 lds
    v_mfma_f32_16x16x32_bf16 v[56:59], a[16:19], a[80:83], v[56:59]
    ds_read_b128 a[48:51], v242 offset:4096
    v_mfma_f32_16x16x32_bf16 v[56:59], a[20:23], a[84:87], v[56:59]
    ds_read_b64_tr_b16 a[10:11], v238 offset:36864
    v_mfma_f32_16x16x32_bf16 v[72:75], a[16:19], a[88:91], v[72:75]
    buffer_load_dwordx4 v229, s[28:31], s56 offen offset:1024 lds
    v_mfma_f32_16x16x32_bf16 v[72:75], a[20:23], a[92:95], v[72:75]
    ds_read_b128 a[52:55], v242 offset:5120
    v_mfma_f32_16x16x32_bf16 v[88:91], a[16:19], a[96:99], v[88:91]
    ds_read_b64_tr_b16 a[12:13], v238 offset:40960
    v_mfma_f32_16x16x32_bf16 v[88:91], a[20:23], a[100:103], v[88:91]
    ds_read_b128 a[56:59], v242 offset:6144
    v_mfma_f32_16x16x32_bf16 v[104:107], a[16:19], a[104:107], v[104:107]
    buffer_load_dwordx4 v230, s[28:31], s56 offen offset:2048 lds
    v_mfma_f32_16x16x32_bf16 v[104:107], a[20:23], a[108:111], v[104:107]
    ds_read_b64_tr_b16 a[14:15], v238 offset:45056
    ds_read_b128 a[60:63], v242 offset:7168
    v_mfma_f32_16x16x32_bf16 v[44:47], a[24:27], a[72:75], v[44:47]
    ds_read_b64_tr_b16 a[16:17], v239 offset:32768
    v_mfma_f32_16x16x32_bf16 v[44:47], a[28:31], a[76:79], v[44:47]
    buffer_load_dwordx4 v231, s[28:31], s56 offen offset:3072 lds
    v_mfma_f32_16x16x32_bf16 v[60:63], a[24:27], a[80:83], v[60:63]
    ds_read_b128 a[64:67], v242 offset:8192
    v_mfma_f32_16x16x32_bf16 v[60:63], a[28:31], a[84:87], v[60:63]
    ds_read_b64_tr_b16 a[18:19], v239 offset:36864
    v_mfma_f32_16x16x32_bf16 v[76:79], a[24:27], a[88:91], v[76:79]
    ds_read_b128 a[68:71], v242 offset:9216
    v_mfma_f32_16x16x32_bf16 v[76:79], a[28:31], a[92:95], v[76:79]
    v_mfma_f32_16x16x32_bf16 v[92:95], a[24:27], a[96:99], v[92:95]
    ds_read_b64_tr_b16 a[20:21], v239 offset:40960
    v_mfma_f32_16x16x32_bf16 v[92:95], a[28:31], a[100:103], v[92:95]
    v_mfma_f32_16x16x32_bf16 v[108:111], a[24:27], a[104:107], v[108:111]
    ds_read_b64_tr_b16 a[22:23], v239 offset:45056
    v_mfma_f32_16x16x32_bf16 v[108:111], a[28:31], a[108:111], v[108:111]
    s_waitcnt lgkmcnt(15)
    v_mfma_f32_16x16x32_bf16 v[32:35], a[0:3], a[32:35], v[32:35]
    ds_read_b64_tr_b16 a[24:25], v240 offset:32768
    v_mfma_f32_16x16x32_bf16 v[32:35], a[4:7], a[36:39], v[32:35]
    v_mfma_f32_16x16x32_bf16 v[48:51], a[0:3], a[40:43], v[48:51]
    ds_read_b64_tr_b16 a[26:27], v240 offset:36864
    s_waitcnt lgkmcnt(15)
    v_mfma_f32_16x16x32_bf16 v[48:51], a[4:7], a[44:47], v[48:51]
    ds_read_b64_tr_b16 a[28:29], v240 offset:40960
    s_waitcnt lgkmcnt(15)
    v_mfma_f32_16x16x32_bf16 v[64:67], a[0:3], a[48:51], v[64:67]
    s_waitcnt lgkmcnt(13)
    v_mfma_f32_16x16x32_bf16 v[64:67], a[4:7], a[52:55], v[64:67]
    ds_read_b64_tr_b16 a[30:31], v240 offset:45056
    s_waitcnt lgkmcnt(12)
    v_mfma_f32_16x16x32_bf16 v[80:83], a[0:3], a[56:59], v[80:83]
    s_waitcnt lgkmcnt(10)
    v_mfma_f32_16x16x32_bf16 v[80:83], a[4:7], a[60:63], v[80:83]
    s_waitcnt lgkmcnt(8)
    v_mfma_f32_16x16x32_bf16 v[96:99], a[0:3], a[64:67], v[96:99]
    s_waitcnt lgkmcnt(6)
    v_mfma_f32_16x16x32_bf16 v[96:99], a[4:7], a[68:71], v[96:99]
    s_waitcnt vmcnt(5)
    v_cmp_eq_u32 vcc, 1, v28
    s_waitcnt lgkmcnt(0)
    s_barrier
    s_nop 1
    s_andn2_b32 s61, s101, vcc_lo
    s_cbranch_scc1 Lgrp_wait
Lgrp_ok:
    v_mfma_f32_16x16x32_bf16 v[36:39], a[8:11], a[32:35], v[36:39]
    ds_read_b64_tr_b16 a[0:1], v237 offset:49152
    s_mov_b32 s61, 0
    v_mfma_f32_16x16x32_bf16 v[36:39], a[12:15], a[36:39], v[36:39]
    s_lshr_b32 s62, s61, 2
    s_cmp_ge_u32 s62, s52
    s_addc_u32 s62, s62, 0
    v_mfma_f32_16x16x32_bf16 v[52:55], a[8:11], a[40:43], v[52:55]
    ds_read_b128 a[72:75], v242 offset:20480
    s_add_u32 s61, s61, s52
    v_mfma_f32_16x16x32_bf16 v[52:55], a[12:15], a[44:47], v[52:55]
    ds_read_b64_tr_b16 a[2:3], v237 offset:53248
    s_and_b32 s61, s61, 3
    v_mfma_f32_16x16x32_bf16 v[68:71], a[8:11], a[48:51], v[68:71]
    ds_read_b128 a[76:79], v242 offset:21504
    s_lshl2_add_u32 s61, s62, s61
    v_mfma_f32_16x16x32_bf16 v[68:71], a[12:15], a[52:55], v[68:71]
    ds_read_b128 a[80:83], v242 offset:22528
    s_lshl_b32 s55, s61, 11
    s_lshl_b32 s56, s61, 17
    v_mfma_f32_16x16x32_bf16 v[84:87], a[8:11], a[56:59], v[84:87]
    ds_read_b64_tr_b16 a[4:5], v237 offset:57344
    s_add_u32 m0, s90, 65536
    v_mfma_f32_16x16x32_bf16 v[84:87], a[12:15], a[60:63], v[84:87]
    buffer_load_dwordx4 v232, s[40:43], s55 offen offset:0 sc1 lds
    v_mfma_f32_16x16x32_bf16 v[100:103], a[8:11], a[64:67], v[100:103]
    buffer_load_dwordx4 v233, s[40:43], s55 offen offset:1024 sc1 lds
    ds_read_b64_tr_b16 a[6:7], v237 offset:61440
    v_mfma_f32_16x16x32_bf16 v[100:103], a[12:15], a[68:71], v[100:103]
    buffer_load_dwordx4 v234, s[40:43], s55 offen offset:2048 sc1 lds
    ds_read_b128 a[84:87], v242 offset:23552
    v_mfma_f32_16x16x32_bf16 v[40:43], a[16:19], a[32:35], v[40:43]
    buffer_load_dwordx4 v235, s[40:43], s55 offen offset:3072 sc1 lds
    ds_read_b128 a[88:91], v242 offset:24576
    v_mfma_f32_16x16x32_bf16 v[40:43], a[20:23], a[36:39], v[40:43]
    ds_read_b64_tr_b16 a[8:9], v238 offset:49152
    s_add_u32 m0, s90, 69632
    v_mfma_f32_16x16x32_bf16 v[56:59], a[16:19], a[40:43], v[56:59]
    buffer_load_dwordx4 v236, s[40:43], s55 offen offset:0 sc1 lds
    v_mfma_f32_16x16x32_bf16 v[56:59], a[20:23], a[44:47], v[56:59]
    ds_read_b128 a[92:95], v242 offset:25600
    s_mov_b32 s61, 1
    s_lshr_b32 s62, s61, 2
    v_mfma_f32_16x16x32_bf16 v[72:75], a[16:19], a[48:51], v[72:75]
    s_cmp_ge_u32 s62, s52
    s_addc_u32 s62, s62, 0
    s_add_u32 s61, s61, s52
    v_mfma_f32_16x16x32_bf16 v[72:75], a[20:23], a[52:55], v[72:75]
    ds_read_b64_tr_b16 a[10:11], v238 offset:53248
    s_and_b32 s61, s61, 3
    v_mfma_f32_16x16x32_bf16 v[88:91], a[16:19], a[56:59], v[88:91]
    ds_read_b64_tr_b16 a[12:13], v238 offset:57344
    s_lshl2_add_u32 s61, s62, s61
    v_mfma_f32_16x16x32_bf16 v[88:91], a[20:23], a[60:63], v[88:91]
    ds_read_b128 a[96:99], v242 offset:26624
    s_lshl_b32 s55, s61, 11
    s_lshl_b32 s56, s61, 17
    v_mfma_f32_16x16x32_bf16 v[104:107], a[16:19], a[64:67], v[104:107]
    ds_read_b64_tr_b16 a[14:15], v238 offset:61440
    s_add_u32 m0, s90, 86016
    v_mfma_f32_16x16x32_bf16 v[104:107], a[20:23], a[68:71], v[104:107]
    buffer_load_dwordx4 v232, s[40:43], s55 offen offset:0 sc1 lds
    ds_read_b128 a[100:103], v242 offset:27648
    v_mfma_f32_16x16x32_bf16 v[44:47], a[24:27], a[32:35], v[44:47]
    buffer_load_dwordx4 v233, s[40:43], s55 offen offset:1024 sc1 lds
    v_mfma_f32_16x16x32_bf16 v[44:47], a[28:31], a[36:39], v[44:47]
    buffer_load_dwordx4 v234, s[40:43], s55 offen offset:2048 sc1 lds
    ds_read_b128 a[104:107], v242 offset:28672
    v_mfma_f32_16x16x32_bf16 v[60:63], a[24:27], a[40:43], v[60:63]
    buffer_load_dwordx4 v235, s[40:43], s55 offen offset:3072 sc1 lds
    ds_read_b128 a[108:111], v242 offset:29696
    v_mfma_f32_16x16x32_bf16 v[60:63], a[28:31], a[44:47], v[60:63]
    ds_read_b64_tr_b16 a[16:17], v239 offset:49152
    s_add_u32 m0, s90, 90112
    v_mfma_f32_16x16x32_bf16 v[76:79], a[24:27], a[48:51], v[76:79]
    buffer_load_dwordx4 v236, s[40:43], s55 offen offset:0 sc1 lds
    ds_read_b64_tr_b16 a[18:19], v239 offset:53248
    v_mfma_f32_16x16x32_bf16 v[76:79], a[28:31], a[52:55], v[76:79]
    s_mov_b32 s61, 2
    s_lshr_b32 s62, s61, 2
    v_mfma_f32_16x16x32_bf16 v[92:95], a[24:27], a[56:59], v[92:95]
    s_cmp_ge_u32 s62, s52
    s_addc_u32 s62, s62, 0
    s_add_u32 s61, s61, s52
    v_mfma_f32_16x16x32_bf16 v[92:95], a[28:31], a[60:63], v[92:95]
    ds_read_b64_tr_b16 a[20:21], v239 offset:57344
    s_and_b32 s61, s61, 3
    v_mfma_f32_16x16x32_bf16 v[108:111], a[24:27], a[64:67], v[108:111]
    ds_read_b64_tr_b16 a[22:23], v239 offset:61440
    s_lshl2_add_u32 s61, s62, s61
    v_mfma_f32_16x16x32_bf16 v[108:111], a[28:31], a[68:71], v[108:111]
    s_lshl_b32 s55, s61, 11
    s_lshl_b32 s56, s61, 17
    s_waitcnt lgkmcnt(15)
    v_mfma_f32_16x16x32_bf16 v[32:35], a[0:3], a[72:75], v[32:35]
    ds_read_b64_tr_b16 a[24:25], v240 offset:49152
    s_add_u32 m0, s95, 32768
    v_mfma_f32_16x16x32_bf16 v[32:35], a[4:7], a[76:79], v[32:35]
    buffer_load_dwordx4 v228, s[28:31], s56 offen offset:0 lds
    v_mfma_f32_16x16x32_bf16 v[48:51], a[0:3], a[80:83], v[48:51]
    buffer_load_dwordx4 v229, s[28:31], s56 offen offset:1024 lds
    ds_read_b64_tr_b16 a[26:27], v240 offset:53248
    s_waitcnt lgkmcnt(15)
    v_mfma_f32_16x16x32_bf16 v[48:51], a[4:7], a[84:87], v[48:51]
    buffer_load_dwordx4 v230, s[28:31], s56 offen offset:2048 lds
    v_mfma_f32_16x16x32_bf16 v[64:67], a[0:3], a[88:91], v[64:67]
    buffer_load_dwordx4 v231, s[28:31], s56 offen offset:3072 lds
    s_waitcnt lgkmcnt(13)
    v_mfma_f32_16x16x32_bf16 v[64:67], a[4:7], a[92:95], v[64:67]
    ds_read_b64_tr_b16 a[28:29], v240 offset:57344
    ds_read_b64_tr_b16 a[30:31], v240 offset:61440
    s_add_u32 m0, s90, 106496
    s_waitcnt lgkmcnt(12)
    v_mfma_f32_16x16x32_bf16 v[80:83], a[0:3], a[96:99], v[80:83]
    buffer_load_dwordx4 v232, s[40:43], s55 offen offset:0 sc1 lds
    s_waitcnt lgkmcnt(10)
    v_mfma_f32_16x16x32_bf16 v[80:83], a[4:7], a[100:103], v[80:83]
    buffer_load_dwordx4 v233, s[40:43], s55 offen offset:1024 sc1 lds
    s_waitcnt lgkmcnt(9)
    v_mfma_f32_16x16x32_bf16 v[96:99], a[0:3], a[104:107], v[96:99]
    buffer_load_dwordx4 v234, s[40:43], s55 offen offset:2048 sc1 lds
    s_waitcnt lgkmcnt(8)
    v_mfma_f32_16x16x32_bf16 v[96:99], a[4:7], a[108:111], v[96:99]
    buffer_load_dwordx4 v235, s[40:43], s55 offen offset:3072 sc1 lds
    s_add_u32 m0, s90, 110592
    s_nop 0
    buffer_load_dwordx4 v236, s[40:43], s55 offen offset:0 sc1 lds
    s_mov_b32 s53, 7
    s_waitcnt vmcnt(14) lgkmcnt(0)
    s_barrier
    v_mfma_f32_16x16x32_bf16 v[36:39], a[8:11], a[72:75], v[36:39]
    ds_read_b128 a[32:35], v241 offset:0
    s_sub_u32 s61, s53, 4
    v_mfma_f32_16x16x32_bf16 v[36:39], a[12:15], a[76:79], v[36:39]
    ds_read_b64_tr_b16 a[0:1], v237 offset:0
    s_lshr_b32 s62, s61, 2
    v_mfma_f32_16x16x32_bf16 v[52:55], a[8:11], a[80:83], v[52:55]
    s_cmp_ge_u32 s62, s52
    s_addc_u32 s62, s62, 0
    v_mfma_f32_16x16x32_bf16 v[52:55], a[12:15], a[84:87], v[52:55]
    ds_read_b64_tr_b16 a[2:3], v237 offset:4096
    s_add_u32 s61, s61, s52
    v_mfma_f32_16x16x32_bf16 v[68:71], a[8:11], a[88:91], v[68:71]
    ds_read_b128 a[36:39], v241 offset:1024
    s_and_b32 s61, s61, 3
    v_mfma_f32_16x16x32_bf16 v[68:71], a[12:15], a[92:95], v[68:71]
    ds_read_b128 a[40:43], v241 offset:2048
    v_mfma_f32_16x16x32_bf16 v[84:87], a[8:11], a[96:99], v[84:87]
    ds_read_b64_tr_b16 a[4:5], v237 offset:8192
    s_lshl2_add_u32 s61, s62, s61
    v_mfma_f32_16x16x32_bf16 v[84:87], a[12:15], a[100:103], v[84:87]
    s_lshl_b32 s55, s61, 11
    v_mfma_f32_16x16x32_bf16 v[100:103], a[8:11], a[104:107], v[100:103]
    ds_read_b64_tr_b16 a[6:7], v237 offset:12288
    s_lshl_b32 s56, s61, 17
    v_mfma_f32_16x16x32_bf16 v[100:103], a[12:15], a[108:111], v[100:103]
    ds_read_b128 a[44:47], v241 offset:3072
    s_add_u32 s53, s53, 1
    v_mfma_f32_16x16x32_bf16 v[40:43], a[16:19], a[72:75], v[40:43]
    ds_read_b128 a[48:51], v241 offset:4096
    v_mfma_f32_16x16x32_bf16 v[40:43], a[20:23], a[76:79], v[40:43]
    ds_read_b64_tr_b16 a[8:9], v238 offset:0
    s_add_u32 m0, s95, 49152
    v_mfma_f32_16x16x32_bf16 v[56:59], a[16:19], a[80:83], v[56:59]
    ds_read_b128 a[52:55], v241 offset:5120
    v_mfma_f32_16x16x32_bf16 v[56:59], a[20:23], a[84:87], v[56:59]
    buffer_load_dwordx4 v228, s[28:31], s56 offen offset:0 lds
    v_mfma_f32_16x16x32_bf16 v[72:75], a[16:19], a[88:91], v[72:75]
    ds_read_b64_tr_b16 a[10:11], v238 offset:4096
    v_mfma_f32_16x16x32_bf16 v[72:75], a[20:23], a[92:95], v[72:75]
    ds_read_b64_tr_b16 a[12:13], v238 offset:8192
    v_mfma_f32_16x16x32_bf16 v[88:91], a[16:19], a[96:99], v[88:91]
    buffer_load_dwordx4 v229, s[28:31], s56 offen offset:1024 lds
    v_mfma_f32_16x16x32_bf16 v[88:91], a[20:23], a[100:103], v[88:91]
    ds_read_b128 a[56:59], v241 offset:6144
    v_mfma_f32_16x16x32_bf16 v[104:107], a[16:19], a[104:107], v[104:107]
    buffer_load_dwordx4 v230, s[28:31], s56 offen offset:2048 lds
    v_mfma_f32_16x16x32_bf16 v[104:107], a[20:23], a[108:111], v[104:107]
    ds_read_b64_tr_b16 a[14:15], v238 offset:12288
    ds_read_b128 a[60:63], v241 offset:7168
    v_mfma_f32_16x16x32_bf16 v[44:47], a[24:27], a[72:75], v[44:47]
    ds_read_b64_tr_b16 a[16:17], v239 offset:0
    v_mfma_f32_16x16x32_bf16 v[44:47], a[28:31], a[76:79], v[44:47]
    buffer_load_dwordx4 v231, s[28:31], s56 offen offset:3072 lds
    v_mfma_f32_16x16x32_bf16 v[60:63], a[24:27], a[80:83], v[60:63]
    ds_read_b128 a[64:67], v241 offset:8192
    v_mfma_f32_16x16x32_bf16 v[60:63], a[28:31], a[84:87], v[60:63]
    ds_read_b64_tr_b16 a[18:19], v239 offset:4096
    s_add_u32 m0, s90, 126976
    v_mfma_f32_16x16x32_bf16 v[76:79], a[24:27], a[88:91], v[76:79]
    ds_read_b128 a[68:71], v241 offset:9216
    v_mfma_f32_16x16x32_bf16 v[76:79], a[28:31], a[92:95], v[76:79]
    ds_read_b64_tr_b16 a[20:21], v239 offset:8192
    v_mfma_f32_16x16x32_bf16 v[92:95], a[24:27], a[96:99], v[92:95]
    buffer_load_dwordx4 v232, s[40:43], s55 offen offset:0 sc1 lds
    v_mfma_f32_16x16x32_bf16 v[92:95], a[28:31], a[100:103], v[92:95]
    v_mfma_f32_16x16x32_bf16 v[108:111], a[24:27], a[104:107], v[108:111]
    buffer_load_dwordx4 v233, s[40:43], s55 offen offset:1024 sc1 lds
    v_mfma_f32_16x16x32_bf16 v[108:111], a[28:31], a[108:111], v[108:111]
    ds_read_b64_tr_b16 a[22:23], v239 offset:12288
    s_waitcnt lgkmcnt(15)
    v_mfma_f32_16x16x32_bf16 v[32:35], a[0:3], a[32:35], v[32:35]
    ds_read_b64_tr_b16 a[24:25], v240 offset:0
    v_mfma_f32_16x16x32_bf16 v[32:35], a[4:7], a[36:39], v[32:35]
    buffer_load_dwordx4 v234, s[40:43], s55 offen offset:2048 sc1 lds
    v_mfma_f32_16x16x32_bf16 v[48:51], a[0:3], a[40:43], v[48:51]
    ds_read_b64_tr_b16 a[26:27], v240 offset:4096
    s_waitcnt lgkmcnt(15)
    v_mfma_f32_16x16x32_bf16 v[48:51], a[4:7], a[44:47], v[48:51]
    buffer_load_dwordx4 v235, s[40:43], s55 offen offset:3072 sc1 lds
    v_mfma_f32_16x16x32_bf16 v[64:67], a[0:3], a[48:51], v[64:67]
    ds_read_b64_tr_b16 a[28:29], v240 offset:8192
    s_waitcnt lgkmcnt(14)
    v_mfma_f32_16x16x32_bf16 v[64:67], a[4:7], a[52:55], v[64:67]
    ds_read_b64_tr_b16 a[30:31], v240 offset:12288
    s_waitcnt lgkmcnt(12)
    v_mfma_f32_16x16x32_bf16 v[80:83], a[0:3], a[56:59], v[80:83]
    s_add_u32 m0, s90, 131072
    s_waitcnt lgkmcnt(10)
    v_mfma_f32_16x16x32_bf16 v[80:83], a[4:7], a[60:63], v[80:83]
    s_waitcnt lgkmcnt(8)
    v_mfma_f32_16x16x32_bf16 v[96:99], a[0:3], a[64:67], v[96:99]
    buffer_load_dwordx4 v236, s[40:43], s55 offen offset:0 sc1 lds
    s_waitcnt lgkmcnt(6)
    v_mfma_f32_16x16x32_bf16 v[96:99], a[4:7], a[68:71], v[96:99]
Lp2_loop:
    s_waitcnt vmcnt(18) lgkmcnt(0)
    s_barrier
    v_mfma_f32_16x16x32_bf16 v[36:39], a[8:11], a[32:35], v[36:39]
    ds_read_b128 a[72:75], v241 offset:20480
    s_sub_u32 s61, s53, 4
    v_mfma_f32_16x16x32_bf16 v[36:39], a[12:15], a[36:39], v[36:39]
    ds_read_b64_tr_b16 a[0:1], v237 offset:16384
    s_lshr_b32 s62, s61, 2
    v_mfma_f32_16x16x32_bf16 v[52:55], a[8:11], a[40:43], v[52:55]
    s_cmp_ge_u32 s62, s52
    s_addc_u32 s62, s62, 0
    v_mfma_f32_16x16x32_bf16 v[52:55], a[12:15], a[44:47], v[52:55]
    ds_read_b64_tr_b16 a[2:3], v237 offset:20480
    s_add_u32 s61, s61, s52
    v_mfma_f32_16x16x32_bf16 v[68:71], a[8:11], a[48:51], v[68:71]
    ds_read_b128 a[76:79], v241 offset:21504
    s_and_b32 s61, s61, 3
    v_mfma_f32_16x16x32_bf16 v[68:71], a[12:15], a[52:55], v[68:71]
    ds_read_b128 a[80:83], v241 offset:22528
    v_mfma_f32_16x16x32_bf16 v[84:87], a[8:11], a[56:59], v[84:87]
    ds_read_b64_tr_b16 a[4:5], v237 offset:24576
    s_lshl2_add_u32 s61, s62, s61
    v_mfma_f32_16x16x32_bf16 v[84:87], a[12:15], a[60:63], v[84:87]
    s_lshl_b32 s55, s61, 11
    v_mfma_f32_16x16x32_bf16 v[100:103], a[8:11], a[64:67], v[100:103]
    ds_read_b64_tr_b16 a[6:7], v237 offset:28672
    s_lshl_b32 s56, s61, 17
    v_mfma_f32_16x16x32_bf16 v[100:103], a[12:15], a[68:71], v[100:103]
    ds_read_b128 a[84:87], v241 offset:23552
    s_add_u32 s53, s53, 1
    v_mfma_f32_16x16x32_bf16 v[40:43], a[16:19], a[32:35], v[40:43]
    ds_read_b128 a[88:91], v241 offset:24576
    v_mfma_f32_16x16x32_bf16 v[40:43], a[20:23], a[36:39], v[40:43]
    ds_read_b64_tr_b16 a[8:9], v238 offset:16384
    s_add_u32 m0, s95, 0
    v_mfma_f32_16x16x32_bf16 v[56:59], a[16:19], a[40:43], v[56:59]
    ds_read_b128 a[92:95], v241 offset:25600
    v_mfma_f32_16x16x32_bf16 v[56:59], a[20:23], a[44:47], v[56:59]
    buffer_load_dwordx4 v228, s[28:31], s56 offen offset:0 lds
    v_mfma_f32_16x16x32_bf16 v[72:75], a[16:19], a[48:51], v[72:75]
    ds_read_b64_tr_b16 a[10:11], v238 offset:20480
    v_mfma_f32_16x16x32_bf16 v[72:75], a[20:23], a[52:55], v[72:75]
    ds_read_b64_tr_b16 a[12:13], v238 offset:24576
    v_mfma_f32_16x16x32_bf16 v[88:91], a[16:19], a[56:59], v[88:91]
    buffer_load_dwordx4 v229, s[28:31], s56 offen offset:1024 lds
    v_mfma_f32_16x16x32_bf16 v[88:91], a[20:23], a[60:63], v[88:91]
    ds_read_b128 a[96:99], v241 offset:26624
    v_mfma_f32_16x16x32_bf16 v[104:107], a[16:19], a[64:67], v[104:107]
    buffer_load_dwordx4 v230, s[28:31], s56 offen offset:2048 lds
    v_mfma_f32_16x16x32_bf16 v[104:107], a[20:23], a[68:71], v[104:107]
    ds_read_b64_tr_b16 a[14:15], v238 offset:28672
    ds_read_b128 a[100:103], v241 offset:27648
    v_mfma_f32_16x16x32_bf16 v[44:47], a[24:27], a[32:35], v[44:47]
    ds_read_b64_tr_b16 a[16:17], v239 offset:16384
    v_mfma_f32_16x16x32_bf16 v[44:47], a[28:31], a[36:39], v[44:47]
    buffer_load_dwordx4 v231, s[28:31], s56 offen offset:3072 lds
    v_mfma_f32_16x16x32_bf16 v[60:63], a[24:27], a[40:43], v[60:63]
    ds_read_b128 a[104:107], v241 offset:28672
    v_mfma_f32_16x16x32_bf16 v[60:63], a[28:31], a[44:47], v[60:63]
    ds_read_b64_tr_b16 a[18:19], v239 offset:20480
    s_add_u32 m0, s90, 65536
    v_mfma_f32_16x16x32_bf16 v[76:79], a[24:27], a[48:51], v[76:79]
    ds_read_b128 a[108:111], v241 offset:29696
    v_mfma_f32_16x16x32_bf16 v[76:79], a[28:31], a[52:55], v[76:79]
    ds_read_b64_tr_b16 a[20:21], v239 offset:24576
    v_mfma_f32_16x16x32_bf16 v[92:95], a[24:27], a[56:59], v[92:95]
    buffer_load_dwordx4 v232, s[40:43], s55 offen offset:0 sc1 lds
    v_mfma_f32_16x16x32_bf16 v[92:95], a[28:31], a[60:63], v[92:95]
    v_mfma_f32_16x16x32_bf16 v[108:111], a[24:27], a[64:67], v[108:111]
    buffer_load_dwordx4 v233, s[40:43], s55 offen offset:1024 sc1 lds
    v_mfma_f32_16x16x32_bf16 v[108:111], a[28:31], a[68:71], v[108:111]
    ds_read_b64_tr_b16 a[22:23], v239 offset:28672
    s_waitcnt lgkmcnt(15)
    v_mfma_f32_16x16x32_bf16 v[32:35], a[0:3], a[72:75], v[32:35]
    ds_read_b64_tr_b16 a[24:25], v240 offset:16384
    v_mfma_f32_16x16x32_bf16 v[32:35], a[4:7], a[76:79], v[32:35]
    buffer_load_dwordx4 v234, s[40:43], s55 offen offset:2048 sc1 lds
    v_mfma_f32_16x16x32_bf16 v[48:51], a[0:3], a[80:83], v[48:51]
    ds_read_b64_tr_b16 a[26:27], v240 offset:20480
    s_waitcnt lgkmcnt(15)
    v_mfma_f32_16x16x32_bf16 v[48:51], a[4:7], a[84:87], v[48:51]
    buffer_load_dwordx4 v235, s[40:43], s55 offen offset:3072 sc1 lds
    v_mfma_f32_16x16x32_bf16 v[64:67], a[0:3], a[88:91], v[64:67]
    ds_read_b64_tr_b16 a[28:29], v240 offset:24576
    s_waitcnt lgkmcnt(14)
    v_mfma_f32_16x16x32_bf16 v[64:67], a[4:7], a[92:95], v[64:67]
    ds_read_b64_tr_b16 a[30:31], v240 offset:28672
    s_waitcnt lgkmcnt(12)
    v_mfma_f32_16x16x32_bf16 v[80:83], a[0:3], a[96:99], v[80:83]
    s_add_u32 m0, s90, 69632
    s_waitcnt lgkmcnt(10)
    v_mfma_f32_16x16x32_bf16 v[80:83], a[4:7], a[100:103], v[80:83]
    s_waitcnt lgkmcnt(8)
    v_mfma_f32_16x16x32_bf16 v[96:99], a[0:3], a[104:107], v[96:99]
    buffer_load_dwordx4 v236, s[40:43], s55 offen offset:0 sc1 lds
    s_waitcnt lgkmcnt(6)
    v_mfma_f32_16x16x32_bf16 v[96:99], a[4:7], a[108:111], v[96:99]
    s_waitcnt vmcnt(18) lgkmcnt(0)
    s_barrier
    v_mfma_f32_16x16x32_bf16 v[36:39], a[8:11], a[72:75], v[36:39]
    ds_read_b128 a[32:35], v242 offset:0
    s_sub_u32 s61, s53, 4
    v_mfma_f32_16x16x32_bf16 v[36:39], a[12:15], a[76:79], v[36:39]
    ds_read_b64_tr_b16 a[0:1], v237 offset:32768
    s_lshr_b32 s62, s61, 2
    v_mfma_f32_16x16x32_bf16 v[52:55], a[8:11], a[80:83], v[52:55]
    s_cmp_ge_u32 s62, s52
    s_addc_u32 s62, s62, 0
    v_mfma_f32_16x16x32_bf16 v[52:55], a[12:15], a[84:87], v[52:55]
    ds_read_b64_tr_b16 a[2:3], v237 offset:36864
    s_add_u32 s61, s61, s52
    v_mfma_f32_16x16x32_bf16 v[68:71], a[8:11], a[88:91], v[68:71]
    ds_read_b128 a[36:39], v242 offset:1024
    s_and_b32 s61, s61, 3
    v_mfma_f32_16x16x32_bf16 v[68:71], a[12:15], a[92:95], v[68:71]
    ds_read_b128 a[40:43], v242 offset:2048
    v_mfma_f32_16x16x32_bf16 v[84:87], a[8:11], a[96:99], v[84:87]
    ds_read_b64_tr_b16 a[4:5], v237 offset:40960
    s_lshl2_add_u32 s61, s62, s61
    v_mfma_f32_16x16x32_bf16 v[84:87], a[12:15], a[100:103], v[84:87]
    s_lshl_b32 s55, s61, 11
    v_mfma_f32_16x16x32_bf16 v[100:103], a[8:11], a[104:107], v[100:103]
    ds_read_b64_tr_b16 a[6:7], v237 offset:45056
    s_lshl_b32 s56, s61, 17
    v_mfma_f32_16x16x32_bf16 v[100:103], a[12:15], a[108:111], v[100:103]
    ds_read_b128 a[44:47], v242 offset:3072
    s_add_u32 s53, s53, 1
    v_mfma_f32_16x16x32_bf16 v[40:43], a[16:19], a[72:75], v[40:43]
    ds_read_b128 a[48:51], v242 offset:4096
    v_mfma_f32_16x16x32_bf16 v[40:43], a[20:23], a[76:79], v[40:43]
    ds_read_b64_tr_b16 a[8:9], v238 offset:32768
    s_add_u32 m0, s95, 16384
    v_mfma_f32_16x16x32_bf16 v[56:59], a[16:19], a[80:83], v[56:59]
    ds_read_b128 a[52:55], v242 offset:5120
    v_mfma_f32_16x16x32_bf16 v[56:59], a[20:23], a[84:87], v[56:59]
    buffer_load_dwordx4 v228, s[28:31], s56 offen offset:0 lds
    v_mfma_f32_16x16x32_bf16 v[72:75], a[16:19], a[88:91], v[72:75]
    ds_read_b64_tr_b16 a[10:11], v238 offset:36864
    v_mfma_f32_16x16x32_bf16 v[72:75], a[20:23], a[92:95], v[72:75]
    ds_read_b64_tr_b16 a[12:13], v238 offset:40960
    v_mfma_f32_16x16x32_bf16 v[88:91], a[16:19], a[96:99], v[88:91]
    buffer_load_dwordx4 v229, s[28:31], s56 offen offset:1024 lds
    v_mfma_f32_16x16x32_bf16 v[88:91], a[20:23], a[100:103], v[88:91]
    ds_read_b128 a[56:59], v242 offset:6144
    v_mfma_f32_16x16x32_bf16 v[104:107], a[16:19], a[104:107], v[104:107]
    buffer_load_dwordx4 v230, s[28:31], s56 offen offset:2048 lds
    v_mfma_f32_16x16x32_bf16 v[104:107], a[20:23], a[108:111], v[104:107]
    ds_read_b64_tr_b16 a[14:15], v238 offset:45056
    ds_read_b128 a[60:63], v242 offset:7168
    v_mfma_f32_16x16x32_bf16 v[44:47], a[24:27], a[72:75], v[44:47]
    ds_read_b64_tr_b16 a[16:17], v239 offset:32768
    v_mfma_f32_16x16x32_bf16 v[44:47], a[28:31], a[76:79], v[44:47]
    buffer_load_dwordx4 v231, s[28:31], s56 offen offset:3072 lds
    v_mfma_f32_16x16x32_bf16 v[60:63], a[24:27], a[80:83], v[60:63]
    ds_read_b128 a[64:67], v242 offset:8192
    v_mfma_f32_16x16x32_bf16 v[60:63], a[28:31], a[84:87], v[60:63]
    ds_read_b64_tr_b16 a[18:19], v239 offset:36864
    s_add_u32 m0, s90, 86016
    v_mfma_f32_16x16x32_bf16 v[76:79], a[24:27], a[88:91], v[76:79]
    ds_read_b128 a[68:71], v242 offset:9216
    v_mfma_f32_16x16x32_bf16 v[76:79], a[28:31], a[92:95], v[76:79]
    ds_read_b64_tr_b16 a[20:21], v239 offset:40960
    v_mfma_f32_16x16x32_bf16 v[92:95], a[24:27], a[96:99], v[92:95]
    buffer_load_dwordx4 v232, s[40:43], s55 offen offset:0 sc1 lds
    v_mfma_f32_16x16x32_bf16 v[92:95], a[28:31], a[100:103], v[92:95]
    v_mfma_f32_16x16x32_bf16 v[108:111], a[24:27], a[104:107], v[108:111]
    buffer_load_dwordx4 v233, s[40:43], s55 offen offset:1024 sc1 lds
    v_mfma_f32_16x16x32_bf16 v[108:111], a[28:31], a[108:111], v[108:111]
    ds_read_b64_tr_b16 a[22:23], v239 offset:45056
    s_waitcnt lgkmcnt(15)
    v_mfma_f32_16x16x32_bf16 v[32:35], a[0:3], a[32:35], v[32:35]
    ds_read_b64_tr_b16 a[24:25], v240 offset:32768
    v_mfma_f32_16x16x32_bf16 v[32:35], a[4:7], a[36:39], v[32:35]
    buffer_load_dwordx4 v234, s[40:43], s55 offen offset:2048 sc1 lds
    v_mfma_f32_16x16x32_bf16 v[48:51], a[0:3], a[40:43], v[48:51]
    ds_read_b64_tr_b16 a[26:27], v240 offset:36864
    s_waitcnt lgkmcnt(15)
    v_mfma_f32_16x16x32_bf16 v[48:51], a[4:7], a[44:47], v[48:51]
    buffer_load_dwordx4 v235, s[40:43], s55 offen offset:3072 sc1 lds
    v_mfma_f32_16x16x32_bf16 v[64:67], a[0:3], a[48:51], v[64:67]
    ds_read_b64_tr_b16 a[28:29], v240 offset:40960
    s_waitcnt lgkmcnt(14)
    v_mfma_f32_16x16x32_bf16 v[64:67], a[4:7], a[52:55], v[64:67]
    ds_read_b64_tr_b16 a[30:31], v240 offset:45056
    s_waitcnt lgkmcnt(12)
    v_mfma_f32_16x16x32_bf16 v[80:83], a[0:3], a[56:59], v[80:83]
    s_add_u32 m0, s90, 90112
    s_waitcnt lgkmcnt(10)
    v_mfma_f32_16x16x32_bf16 v[80:83], a[4:7], a[60:63], v[80:83]
    s_waitcnt lgkmcnt(8)
    v_mfma_f32_16x16x32_bf16 v[96:99], a[0:3], a[64:67], v[96:99]
    buffer_load_dwordx4 v236, s[40:43], s55 offen offset:0 sc1 lds
    s_waitcnt lgkmcnt(6)
    v_mfma_f32_16x16x32_bf16 v[96:99], a[4:7], a[68:71], v[96:99]
    s_waitcnt vmcnt(18) lgkmcnt(0)
    s_barrier
    v_mfma_f32_16x16x32_bf16 v[36:39], a[8:11], a[32:35], v[36:39]
    ds_read_b128 a[72:75], v242 offset:20480
    s_sub_u32 s61, s53, 4
    v_mfma_f32_16x16x32_bf16 v[36:39], a[12:15], a[36:39], v[36:39]
    ds_read_b64_tr_b16 a[0:1], v237 offset:49152
    s_lshr_b32 s62, s61, 2
    v_mfma_f32_16x16x32_bf16 v[52:55], a[8:11], a[40:43], v[52:55]
    s_cmp_ge_u32 s62, s52
    s_addc_u32 s62, s62, 0
    v_mfma_f32_16x16x32_bf16 v[52:55], a[12:15], a[44:47], v[52:55]
    ds_read_b64_tr_b16 a[2:3], v237 offset:53248
    s_add_u32 s61, s61, s52
    v_mfma_f32_16x16x32_bf16 v[68:71], a[8:11], a[48:51], v[68:71]
    ds_read_b128 a[76:79], v242 offset:21504
    s_and_b32 s61, s61, 3
    v_mfma_f32_16x16x32_bf16 v[68:71], a[12:15], a[52:55], v[68:71]
    ds_read_b128 a[80:83], v242 offset:22528
    v_mfma_f32_16x16x32_bf16 v[84:87], a[8:11], a[56:59], v[84:87]
    ds_read_b64_tr_b16 a[4:5], v237 offset:57344
    s_lshl2_add_u32 s61, s62, s61
    v_mfma_f32_16x16x32_bf16 v[84:87], a[12:15], a[60:63], v[84:87]
    s_lshl_b32 s55, s61, 11
    v_mfma_f32_16x16x32_bf16 v[100:103], a[8:11], a[64:67], v[100:103]
    ds_read_b64_tr_b16 a[6:7], v237 offset:61440
    s_lshl_b32 s56, s61, 17
    v_mfma_f32_16x16x32_bf16 v[100:103], a[12:15], a[68:71], v[100:103]
    ds_read_b128 a[84:87], v242 offset:23552
    s_add_u32 s53, s53, 1
    v_mfma_f32_16x16x32_bf16 v[40:43], a[16:19], a[32:35], v[40:43]
    ds_read_b128 a[88:91], v242 offset:24576
    v_mfma_f32_16x16x32_bf16 v[40:43], a[20:23], a[36:39], v[40:43]
    ds_read_b64_tr_b16 a[8:9], v238 offset:49152
    s_add_u32 m0, s95, 32768
    v_mfma_f32_16x16x32_bf16 v[56:59], a[16:19], a[40:43], v[56:59]
    ds_read_b128 a[92:95], v242 offset:25600
    v_mfma_f32_16x16x32_bf16 v[56:59], a[20:23], a[44:47], v[56:59]
    buffer_load_dwordx4 v228, s[28:31], s56 offen offset:0 lds
    v_mfma_f32_16x16x32_bf16 v[72:75], a[16:19], a[48:51], v[72:75]
    ds_read_b64_tr_b16 a[10:11], v238 offset:53248
    v_mfma_f32_16x16x32_bf16 v[72:75], a[20:23], a[52:55], v[72:75]
    ds_read_b64_tr_b16 a[12:13], v238 offset:57344
    v_mfma_f32_16x16x32_bf16 v[88:91], a[16:19], a[56:59], v[88:91]
    buffer_load_dwordx4 v229, s[28:31], s56 offen offset:1024 lds
    v_mfma_f32_16x16x32_bf16 v[88:91], a[20:23], a[60:63], v[88:91]
    ds_read_b128 a[96:99], v242 offset:26624
    v_mfma_f32_16x16x32_bf16 v[104:107], a[16:19], a[64:67], v[104:107]
    buffer_load_dwordx4 v230, s[28:31], s56 offen offset:2048 lds
    v_mfma_f32_16x16x32_bf16 v[104:107], a[20:23], a[68:71], v[104:107]
    ds_read_b64_tr_b16 a[14:15], v238 offset:61440
    ds_read_b128 a[100:103], v242 offset:27648
    v_mfma_f32_16x16x32_bf16 v[44:47], a[24:27], a[32:35], v[44:47]
    ds_read_b64_tr_b16 a[16:17], v239 offset:49152
    v_mfma_f32_16x16x32_bf16 v[44:47], a[28:31], a[36:39], v[44:47]
    buffer_load_dwordx4 v231, s[28:31], s56 offen offset:3072 lds
    v_mfma_f32_16x16x32_bf16 v[60:63], a[24:27], a[40:43], v[60:63]
    ds_read_b128 a[104:107], v242 offset:28672
    v_mfma_f32_16x16x32_bf16 v[60:63], a[28:31], a[44:47], v[60:63]
    ds_read_b64_tr_b16 a[18:19], v239 offset:53248
    s_add_u32 m0, s90, 106496
    v_mfma_f32_16x16x32_bf16 v[76:79], a[24:27], a[48:51], v[76:79]
    ds_read_b128 a[108:111], v242 offset:29696
    v_mfma_f32_16x16x32_bf16 v[76:79], a[28:31], a[52:55], v[76:79]
    ds_read_b64_tr_b16 a[20:21], v239 offset:57344
    v_mfma_f32_16x16x32_bf16 v[92:95], a[24:27], a[56:59], v[92:95]
    buffer_load_dwordx4 v232, s[40:43], s55 offen offset:0 sc1 lds
    v_mfma_f32_16x16x32_bf16 v[92:95], a[28:31], a[60:63], v[92:95]
    v_mfma_f32_16x16x32_bf16 v[108:111], a[24:27], a[64:67], v[108:111]
    buffer_load_dwordx4 v233, s[40:43], s55 offen offset:1024 sc1 lds
    v_mfma_f32_16x16x32_bf16 v[108:111], a[28:31], a[68:71], v[108:111]
    ds_read_b64_tr_b16 a[22:23], v239 offset:61440
    s_waitcnt lgkmcnt(15)
    v_mfma_f32_16x16x32_bf16 v[32:35], a[0:3], a[72:75], v[32:35]
    ds_read_b64_tr_b16 a[24:25], v240 offset:49152
    v_mfma_f32_16x16x32_bf16 v[32:35], a[4:7], a[76:79], v[32:35]
    buffer_load_dwordx4 v234, s[40:43], s55 offen offset:2048 sc1 lds
    v_mfma_f32_16x16x32_bf16 v[48:51], a[0:3], a[80:83], v[48:51]
    ds_read_b64_tr_b16 a[26:27], v240 offset:53248
    s_waitcnt lgkmcnt(15)
    v_mfma_f32_16x16x32_bf16 v[48:51], a[4:7], a[84:87], v[48:51]
    buffer_load_dwordx4 v235, s[40:43], s55 offen offset:3072 sc1 lds
    v_mfma_f32_16x16x32_bf16 v[64:67], a[0:3], a[88:91], v[64:67]
    ds_read_b64_tr_b16 a[28:29], v240 offset:57344
    s_waitcnt lgkmcnt(14)
    v_mfma_f32_16x16x32_bf16 v[64:67], a[4:7], a[92:95], v[64:67]
    ds_read_b64_tr_b16 a[30:31], v240 offset:61440
    s_waitcnt lgkmcnt(12)
    v_mfma_f32_16x16x32_bf16 v[80:83], a[0:3], a[96:99], v[80:83]
    s_add_u32 m0, s90, 110592
    s_waitcnt lgkmcnt(10)
    v_mfma_f32_16x16x32_bf16 v[80:83], a[4:7], a[100:103], v[80:83]
    s_waitcnt lgkmcnt(8)
    v_mfma_f32_16x16x32_bf16 v[96:99], a[0:3], a[104:107], v[96:99]
    buffer_load_dwordx4 v236, s[40:43], s55 offen offset:0 sc1 lds
    s_waitcnt lgkmcnt(6)
    v_mfma_f32_16x16x32_bf16 v[96:99], a[4:7], a[108:111], v[96:99]
    s_waitcnt vmcnt(18) lgkmcnt(0)
    s_barrier
    v_mfma_f32_16x16x32_bf16 v[36:39], a[8:11], a[72:75], v[36:39]
    ds_read_b128 a[32:35], v241 offset:0
    s_sub_u32 s61, s53, 4
    v_mfma_f32_16x16x32_bf16 v[36:39], a[12:15], a[76:79], v[36:39]
    ds_read_b64_tr_b16 a[0:1], v237 offset:0
    s_lshr_b32 s62, s61, 2
    v_mfma_f32_16x16x32_bf16 v[52:55], a[8:11], a[80:83], v[52:55]
    s_cmp_ge_u32 s62, s52
    s_addc_u32 s62, s62, 0
    v_mfma_f32_16x16x32_bf16 v[52:55], a[12:15], a[84:87], v[52:55]
    ds_read_b64_tr_b16 a[2:3], v237 offset:4096
    s_add_u32 s61, s61, s52
    v_mfma_f32_16x16x32_bf16 v[68:71], a[8:11], a[88:91], v[68:71]
    ds_read_b128 a[36:39], v241 offset:1024
    s_and_b32 s61, s61, 3
    v_mfma_f32_16x16x32_bf16 v[68:71], a[12:15], a[92:95], v[68:71]
    ds_read_b128 a[40:43], v241 offset:2048
    v_mfma_f32_16x16x32_bf16 v[84:87], a[8:11], a[96:99], v[84:87]
    ds_read_b64_tr_b16 a[4:5], v237 offset:8192
    s_lshl2_add_u32 s61, s62, s61
    v_mfma_f32_16x16x32_bf16 v[84:87], a[12:15], a[100:103], v[84:87]
    s_lshl_b32 s55, s61, 11
    v_mfma_f32_16x16x32_bf16 v[100:103], a[8:11], a[104:107], v[100:103]
    ds_read_b64_tr_b16 a[6:7], v237 offset:12288
    s_lshl_b32 s56, s61, 17
    v_mfma_f32_16x16x32_bf16 v[100:103], a[12:15], a[108:111], v[100:103]
    ds_read_b128 a[44:47], v241 offset:3072
    s_add_u32 s53, s53, 1
    v_mfma_f32_16x16x32_bf16 v[40:43], a[16:19], a[72:75], v[40:43]
    ds_read_b128 a[48:51], v241 offset:4096
    v_mfma_f32_16x16x32_bf16 v[40:43], a[20:23], a[76:79], v[40:43]
    ds_read_b64_tr_b16 a[8:9], v238 offset:0
    s_add_u32 m0, s95, 49152
    v_mfma_f32_16x16x32_bf16 v[56:59], a[16:19], a[80:83], v[56:59]
    ds_read_b128 a[52:55], v241 offset:5120
    v_mfma_f32_16x16x32_bf16 v[56:59], a[20:23], a[84:87], v[56:59]
    buffer_load_dwordx4 v228, s[28:31], s56 offen offset:0 lds
    v_mfma_f32_16x16x32_bf16 v[72:75], a[16:19], a[88:91], v[72:75]
    ds_read_b64_tr_b16 a[10:11], v238 offset:4096
    v_mfma_f32_16x16x32_bf16 v[72:75], a[20:23], a[92:95], v[72:75]
    ds_read_b64_tr_b16 a[12:13], v238 offset:8192
    v_mfma_f32_16x16x32_bf16 v[88:91], a[16:19], a[96:99], v[88:91]
    buffer_load_dwordx4 v229, s[28:31], s56 offen offset:1024 lds
    v_mfma_f32_16x16x32_bf16 v[88:91], a[20:23], a[100:103], v[88:91]
    ds_read_b128 a[56:59], v241 offset:6144
    v_mfma_f32_16x16x32_bf16 v[104:107], a[16:19], a[104:107], v[104:107]
    buffer_load_dwordx4 v230, s[28:31], s56 offen offset:2048 lds
    v_mfma_f32_16x16x32_bf16 v[104:107], a[20:23], a[108:111], v[104:107]
    ds_read_b64_tr_b16 a[14:15], v238 offset:12288
    ds_read_b128 a[60:63], v241 offset:7168
    v_mfma_f32_16x16x32_bf16 v[44:47], a[24:27], a[72:75], v[44:47]
    ds_read_b64_tr_b16 a[16:17], v239 offset:0
    v_mfma_f32_16x16x32_bf16 v[44:47], a[28:31], a[76:79], v[44:47]
    buffer_load_dwordx4 v231, s[28:31], s56 offen offset:3072 lds
    v_mfma_f32_16x16x32_bf16 v[60:63], a[24:27], a[80:83], v[60:63]
    ds_read_b128 a[64:67], v241 offset:8192
    v_mfma_f32_16x16x32_bf16 v[60:63], a[28:31], a[84:87], v[60:63]
    ds_read_b64_tr_b16 a[18:19], v239 offset:4096
    s_add_u32 m0, s90, 126976
    v_mfma_f32_16x16x32_bf16 v[76:79], a[24:27], a[88:91], v[76:79]
    ds_read_b128 a[68:71], v241 offset:9216
    v_mfma_f32_16x16x32_bf16 v[76:79], a[28:31], a[92:95], v[76:79]
    ds_read_b64_tr_b16 a[20:21], v239 offset:8192
    v_mfma_f32_16x16x32_bf16 v[92:95], a[24:27], a[96:99], v[92:95]
    buffer_load_dwordx4 v232, s[40:43], s55 offen offset:0 sc1 lds
    v_mfma_f32_16x16x32_bf16 v[92:95], a[28:31], a[100:103], v[92:95]
    v_mfma_f32_16x16x32_bf16 v[108:111], a[24:27], a[104:107], v[108:111]
    buffer_load_dwordx4 v233, s[40:43], s55 offen offset:1024 sc1 lds
    v_mfma_f32_16x16x32_bf16 v[108:111], a[28:31], a[108:111], v[108:111]
    ds_read_b64_tr_b16 a[22:23], v239 offset:12288
    s_waitcnt lgkmcnt(15)
    v_mfma_f32_16x16x32_bf16 v[32:35], a[0:3], a[32:35], v[32:35]
    ds_read_b64_tr_b16 a[24:25], v240 offset:0
    v_mfma_f32_16x16x32_bf16 v[32:35], a[4:7], a[36:39], v[32:35]
    buffer_load_dwordx4 v234, s[40:43], s55 offen offset:2048 sc1 lds
    v_mfma_f32_16x16x32_bf16 v[48:51], a[0:3], a[40:43], v[48:51]
    ds_read_b64_tr_b16 a[26:27], v240 offset:4096
    s_waitcnt lgkmcnt(15)
    v_mfma_f32_16x16x32_bf16 v[48:51], a[4:7], a[44:47], v[48:51]
    buffer_load_dwordx4 v235, s[40:43], s55 offen offset:3072 sc1 lds
    v_mfma_f32_16x16x32_bf16 v[64:67], a[0:3], a[48:51], v[64:67]
    ds_read_b64_tr_b16 a[28:29], v240 offset:8192
    s_waitcnt lgkmcnt(14)
    v_mfma_f32_16x16x32_bf16 v[64:67], a[4:7], a[52:55], v[64:67]
    ds_read_b64_tr_b16 a[30:31], v240 offset:12288
    s_waitcnt lgkmcnt(12)
    v_mfma_f32_16x16x32_bf16 v[80:83], a[0:3], a[56:59], v[80:83]
    s_add_u32 m0, s90, 131072
    s_waitcnt lgkmcnt(10)
    v_mfma_f32_16x16x32_bf16 v[80:83], a[4:7], a[60:63], v[80:83]
    s_waitcnt lgkmcnt(8)
    v_mfma_f32_16x16x32_bf16 v[96:99], a[0:3], a[64:67], v[96:99]
    buffer_load_dwordx4 v236, s[40:43], s55 offen offset:0 sc1 lds
    s_waitcnt lgkmcnt(6)
    v_mfma_f32_16x16x32_bf16 v[96:99], a[4:7], a[68:71], v[96:99]
    s_cmp_lt_u32 s53, 32
    s_cbranch_scc1 Lp2_loop
    s_waitcnt vmcnt(18) lgkmcnt(0)
    s_barrier
    v_mfma_f32_16x16x32_bf16 v[36:39], a[8:11], a[32:35], v[36:39]
    ds_read_b128 a[72:75], v241 offset:20480
    v_mfma_f32_16x16x32_bf16 v[36:39], a[12:15], a[36:39], v[36:39]
    v_mfma_f32_16x16x32_bf16 v[52:55], a[8:11], a[40:43], v[52:55]
    ds_read_b128 a[76:79], v241 offset:21504
    v_mfma_f32_16x16x32_bf16 v[52:55], a[12:15], a[44:47], v[52:55]
    ds_read_b64_tr_b16 a[128:129], v239 offset:16384
    v_mfma_f32_16x16x32_bf16 v[68:71], a[8:11], a[48:51], v[68:71]
    v_mfma_f32_16x16x32_bf16 v[68:71], a[12:15], a[52:55], v[68:71]
    ds_read_b64_tr_b16 a[130:131], v239 offset:20480
    v_mfma_f32_16x16x32_bf16 v[84:87], a[8:11], a[56:59], v[84:87]
    ds_read_b64_tr_b16 a[132:133], v239 offset:24576
    v_mfma_f32_16x16x32_bf16 v[84:87], a[12:15], a[60:63], v[84:87]
    ds_read_b64_tr_b16 a[134:135], v239 offset:28672
    v_mfma_f32_16x16x32_bf16 v[100:103], a[8:11], a[64:67], v[100:103]
    v_mfma_f32_16x16x32_bf16 v[100:103], a[12:15], a[68:71], v[100:103]
    ds_read_b128 a[80:83], v241 offset:22528
    v_mfma_f32_16x16x32_bf16 v[40:43], a[16:19], a[32:35], v[40:43]
    ds_read_b128 a[84:87], v241 offset:23552
    v_mfma_f32_16x16x32_bf16 v[40:43], a[20:23], a[36:39], v[40:43]
    v_mfma_f32_16x16x32_bf16 v[56:59], a[16:19], a[40:43], v[56:59]
    ds_read_b128 a[88:91], v241 offset:24576
    v_mfma_f32_16x16x32_bf16 v[56:59], a[20:23], a[44:47], v[56:59]
    ds_read_b128 a[92:95], v241 offset:25600
    v_mfma_f32_16x16x32_bf16 v[72:75], a[16:19], a[48:51], v[72:75]
    v_mfma_f32_16x16x32_bf16 v[72:75], a[20:23], a[52:55], v[72:75]
    ds_read_b128 a[96:99], v241 offset:26624
    v_mfma_f32_16x16x32_bf16 v[88:91], a[16:19], a[56:59], v[88:91]
    ds_read_b128 a[100:103], v241 offset:27648
    v_mfma_f32_16x16x32_bf16 v[88:91], a[20:23], a[60:63], v[88:91]
    v_mfma_f32_16x16x32_bf16 v[104:107], a[16:19], a[64:67], v[104:107]
    ds_read_b128 a[104:107], v241 offset:28672
    v_mfma_f32_16x16x32_bf16 v[104:107], a[20:23], a[68:71], v[104:107]
    ds_read_b128 a[108:111], v241 offset:29696
    v_mfma_f32_16x16x32_bf16 v[44:47], a[24:27], a[32:35], v[44:47]
    ds_read_b64_tr_b16 a[136:137], v240 offset:16384
    v_mfma_f32_16x16x32_bf16 v[44:47], a[28:31], a[36:39], v[44:47]
    v_mfma_f32_16x16x32_bf16 v[60:63], a[24:27], a[40:43], v[60:63]
    ds_read_b64_tr_b16 a[138:139], v240 offset:20480
    v_mfma_f32_16x16x32_bf16 v[60:63], a[28:31], a[44:47], v[60:63]
    ds_read_b64_tr_b16 a[140:141], v240 offset:24576
    v_mfma_f32_16x16x32_bf16 v[76:79], a[24:27], a[48:51], v[76:79]
    v_mfma_f32_16x16x32_bf16 v[76:79], a[28:31], a[52:55], v[76:79]
    s_waitcnt vmcnt(9)
    s_barrier
    ds_read_b64_tr_b16 a[142:143], v240 offset:28672
    v_mfma_f32_16x16x32_bf16 v[92:95], a[24:27], a[56:59], v[92:95]
    ds_read_b128 a[208:211], v242 offset:0
    v_mfma_f32_16x16x32_bf16 v[92:95], a[28:31], a[60:63], v[92:95]
    ds_read_b128 a[212:215], v242 offset:1024
    v_mfma_f32_16x16x32_bf16 v[108:111], a[24:27], a[64:67], v[108:111]
    ds_read_b64_tr_b16 a[160:161], v239 offset:32768
    v_mfma_f32_16x16x32_bf16 v[108:111], a[28:31], a[68:71], v[108:111]
    ds_read_b64_tr_b16 a[162:163], v239 offset:36864
    s_waitcnt lgkmcnt(15)
    v_mfma_f32_16x16x32_bf16 v[40:43], a[128:131], a[72:75], v[40:43]
    ds_read_b64_tr_b16 a[164:165], v239 offset:40960
    v_mfma_f32_16x16x32_bf16 v[40:43], a[132:135], a[76:79], v[40:43]
    v_mfma_f32_16x16x32_bf16 v[56:59], a[128:131], a[80:83], v[56:59]
    ds_read_b64_tr_b16 a[166:167], v239 offset:45056
    s_waitcnt lgkmcnt(15)
    v_mfma_f32_16x16x32_bf16 v[56:59], a[132:135], a[84:87], v[56:59]
    ds_read_b128 a[216:219], v242 offset:2048
    v_mfma_f32_16x16x32_bf16 v[72:75], a[128:131], a[88:91], v[72:75]
    ds_read_b128 a[220:223], v242 offset:3072
    s_waitcnt lgkmcnt(15)
    v_mfma_f32_16x16x32_bf16 v[72:75], a[132:135], a[92:95], v[72:75]
    ds_read_b128 a[224:227], v242 offset:4096
    v_mfma_f32_16x16x32_bf16 v[88:91], a[128:131], a[96:99], v[88:91]
    ds_read_b128 a[228:231], v242 offset:5120
    s_waitcnt lgkmcnt(15)
    v_mfma_f32_16x16x32_bf16 v[88:91], a[132:135], a[100:103], v[88:91]
    ds_read_b128 a[232:235], v242 offset:6144
    v_mfma_f32_16x16x32_bf16 v[104:107], a[128:131], a[104:107], v[104:107]
    ds_read_b128 a[236:239], v242 offset:7168
    s_waitcnt lgkmcnt(15)
    v_mfma_f32_16x16x32_bf16 v[104:107], a[132:135], a[108:111], v[104:107]
    ds_read_b128 a[240:243], v242 offset:8192
    s_waitcnt lgkmcnt(15)
    v_mfma_f32_16x16x32_bf16 v[44:47], a[136:139], a[72:75], v[44:47]
    ds_read_b128 a[244:247], v242 offset:9216
    s_waitcnt lgkmcnt(14)
    v_mfma_f32_16x16x32_bf16 v[44:47], a[140:143], a[76:79], v[44:47]
    v_mfma_f32_16x16x32_bf16 v[60:63], a[136:139], a[80:83], v[60:63]
    ds_read_b64_tr_b16 a[168:169], v240 offset:32768
    v_mfma_f32_16x16x32_bf16 v[60:63], a[140:143], a[84:87], v[60:63]
    ds_read_b64_tr_b16 a[170:171], v240 offset:36864
    v_mfma_f32_16x16x32_bf16 v[76:79], a[136:139], a[88:91], v[76:79]
    ds_read_b64_tr_b16 a[172:173], v240 offset:40960
    v_mfma_f32_16x16x32_bf16 v[76:79], a[140:143], a[92:95], v[76:79]
    s_waitcnt vmcnt(0)
    s_barrier
    ds_read_b64_tr_b16 a[174:175], v240 offset:45056
    v_mfma_f32_16x16x32_bf16 v[92:95], a[136:139], a[96:99], v[92:95]
    ds_read_b128 a[32:35], v242 offset:20480
    v_mfma_f32_16x16x32_bf16 v[92:95], a[140:143], a[100:103], v[92:95]
    ds_read_b128 a[36:39], v242 offset:21504
    v_mfma_f32_16x16x32_bf16 v[108:111], a[136:139], a[104:107], v[108:111]
    ds_read_b64_tr_b16 a[192:193], v239 offset:49152
    v_mfma_f32_16x16x32_bf16 v[108:111], a[140:143], a[108:111], v[108:111]
    ds_read_b64_tr_b16 a[194:195], v239 offset:53248
    s_waitcnt lgkmcnt(15)
    v_mfma_f32_16x16x32_bf16 v[40:43], a[160:163], a[208:211], v[40:43]
    ds_read_b64_tr_b16 a[196:197], v239 offset:57344
    v_mfma_f32_16x16x32_bf16 v[40:43], a[164:167], a[212:215], v[40:43]
    ds_read_b64_tr_b16 a[198:199], v239 offset:61440
    v_mfma_f32_16x16x32_bf16 v[56:59], a[160:163], a[216:219], v[56:59]
    ds_read_b128 a[40:43], v242 offset:22528
    s_waitcnt lgkmcnt(15)
    v_mfma_f32_16x16x32_bf16 v[56:59], a[164:167], a[220:223], v[56:59]
    ds_read_b128 a[44:47], v242 offset:23552
    v_mfma_f32_16x16x32_bf16 v[72:75], a[160:163], a[224:227], v[72:75]
    ds_read_b128 a[48:51], v242 offset:24576
    v_mfma_f32_16x16x32_bf16 v[72:75], a[164:167], a[228:231], v[72:75]
    s_waitcnt lgkmcnt(15)
    v_mfma_f32_16x16x32_bf16 v[88:91], a[160:163], a[232:235], v[88:91]
    ds_read_b128 a[52:55], v242 offset:25600
    v_mfma_f32_16x16x32_bf16 v[88:91], a[164:167], a[236:239], v[88:91]
    ds_read_b128 a[56:59], v242 offset:26624
    s_waitcnt lgkmcnt(15)
    v_mfma_f32_16x16x32_bf16 v[104:107], a[160:163], a[240:243], v[104:107]
    ds_read_b128 a[60:63], v242 offset:27648
    v_mfma_f32_16x16x32_bf16 v[104:107], a[164:167], a[244:247], v[104:107]
    ds_read_b128 a[64:67], v242 offset:28672
    s_waitcnt lgkmcnt(15)
    v_mfma_f32_16x16x32_bf16 v[44:47], a[168:171], a[208:211], v[44:47]
    ds_read_b128 a[68:71], v242 offset:29696
    s_waitcnt lgkmcnt(14)
    v_mfma_f32_16x16x32_bf16 v[44:47], a[172:175], a[212:215], v[44:47]
    ds_read_b64_tr_b16 a[200:201], v240 offset:49152
    v_mfma_f32_16x16x32_bf16 v[60:63], a[168:171], a[216:219], v[60:63]
    ds_read_b64_tr_b16 a[202:203], v240 offset:53248
    v_mfma_f32_16x16x32_bf16 v[60:63], a[172:175], a[220:223], v[60:63]
    ds_read_b64_tr_b16 a[204:205], v240 offset:57344
    v_mfma_f32_16x16x32_bf16 v[76:79], a[168:171], a[224:227], v[76:79]
    ds_read_b64_tr_b16 a[206:207], v240 offset:61440
    s_lshl_b32 s61, s4, 2
    v_mfma_f32_16x16x32_bf16 v[76:79], a[172:175], a[228:231], v[76:79]
    ds_read_b64_tr_b16 a[112:113], v237 offset:16384
    v_mfma_f32_16x16x32_bf16 v[92:95], a[168:171], a[232:235], v[92:95]
    s_add_u32 s61, s61, 64
    v_mfma_f32_16x16x32_bf16 v[92:95], a[172:175], a[236:239], v[92:95]
    ds_read_b64_tr_b16 a[114:115], v237 offset:20480
    v_mfma_f32_16x16x32_bf16 v[108:111], a[168:171], a[240:243], v[108:111]
    ds_read_b64_tr_b16 a[116:117], v237 offset:24576
    s_lshl_b32 s62, s2, 7
    v_mfma_f32_16x16x32_bf16 v[108:111], a[172:175], a[244:247], v[108:111]
    s_waitcnt lgkmcnt(15)
    v_mfma_f32_16x16x32_bf16 v[40:43], a[192:195], a[32:35], v[40:43]
    ds_read_b64_tr_b16 a[118:119], v237 offset:28672
    s_add_u32 s92, s61, s62
    v_mfma_f32_16x16x32_bf16 v[40:43], a[196:199], a[36:39], v[40:43]
    ds_read_b64_tr_b16 a[120:121], v238 offset:16384
    s_waitcnt lgkmcnt(15)
    v_mfma_f32_16x16x32_bf16 v[56:59], a[192:195], a[40:43], v[56:59]
    s_xor_b32 s62, s92, 256
    v_mfma_f32_16x16x32_bf16 v[56:59], a[196:199], a[44:47], v[56:59]
    ds_read_b64_tr_b16 a[122:123], v238 offset:20480
    s_waitcnt lgkmcnt(15)
    v_mfma_f32_16x16x32_bf16 v[72:75], a[192:195], a[48:51], v[72:75]
    ds_read_b64_tr_b16 a[124:125], v238 offset:24576
    v_lshl_add_u32 v26, v0, 24, s62
    s_waitcnt lgkmcnt(15)
    v_mfma_f32_16x16x32_bf16 v[72:75], a[196:199], a[52:55], v[72:75]
    s_waitcnt lgkmcnt(14)
    v_mfma_f32_16x16x32_bf16 v[88:91], a[192:195], a[56:59], v[88:91]
    ds_read_b64_tr_b16 a[126:127], v238 offset:28672
    v_mov_b32 v27, 1
    s_waitcnt lgkmcnt(14)
    v_mfma_f32_16x16x32_bf16 v[88:91], a[196:199], a[60:63], v[88:91]
    ds_read_b64_tr_b16 a[144:145], v237 offset:32768
    s_waitcnt lgkmcnt(14)
    v_mfma_f32_16x16x32_bf16 v[104:107], a[192:195], a[64:67], v[104:107]
    s_mov_b32 s82, 32768
    s_waitcnt lgkmcnt(13)
    v_mfma_f32_16x16x32_bf16 v[104:107], a[196:199], a[68:71], v[104:107]
    ds_read_b64_tr_b16 a[146:147], v237 offset:36864
    s_waitcnt lgkmcnt(12)
    v_mfma_f32_16x16x32_bf16 v[44:47], a[200:203], a[32:35], v[44:47]
    ds_read_b64_tr_b16 a[148:149], v237 offset:40960
    v_cvt_pk_bf16_f32 v40, v40, v41
    s_waitcnt lgkmcnt(11)
    v_mfma_f32_16x16x32_bf16 v[44:47], a[204:207], a[36:39], v[44:47]
    v_cvt_pk_bf16_f32 v41, v42, v43
    v_mfma_f32_16x16x32_bf16 v[60:63], a[200:203], a[40:43], v[60:63]
    ds_read_b64_tr_b16 a[150:151], v237 offset:45056
    v_cvt_pk_bf16_f32 v56, v56, v57
    v_mfma_f32_16x16x32_bf16 v[60:63], a[204:207], a[44:47], v[60:63]
    ds_read_b64_tr_b16 a[152:153], v238 offset:32768
    v_cvt_pk_bf16_f32 v57, v58, v59
    v_mfma_f32_16x16x32_bf16 v[76:79], a[200:203], a[48:51], v[76:79]
    v_cvt_pk_bf16_f32 v72, v72, v73
    v_mfma_f32_16x16x32_bf16 v[76:79], a[204:207], a[52:55], v[76:79]
    ds_read_b64_tr_b16 a[154:155], v238 offset:36864
    v_cvt_pk_bf16_f32 v73, v74, v75
    v_mfma_f32_16x16x32_bf16 v[92:95], a[200:203], a[56:59], v[92:95]
    ds_read_b64_tr_b16 a[156:157], v238 offset:40960
    v_cvt_pk_bf16_f32 v88, v88, v89
    v_mfma_f32_16x16x32_bf16 v[92:95], a[204:207], a[60:63], v[92:95]
    v_cvt_pk_bf16_f32 v89, v90, v91
    v_mfma_f32_16x16x32_bf16 v[108:111], a[200:203], a[64:67], v[108:111]
    ds_read_b64_tr_b16 a[158:159], v238 offset:45056
    v_cvt_pk_bf16_f32 v104, v104, v105
    v_mfma_f32_16x16x32_bf16 v[108:111], a[204:207], a[68:71], v[108:111]
    ds_read_b64_tr_b16 a[176:177], v237 offset:49152
    v_cvt_pk_bf16_f32 v105, v106, v107
    s_waitcnt lgkmcnt(15)
    v_mfma_f32_16x16x32_bf16 v[32:35], a[112:115], a[72:75], v[32:35]
    v_cvt_pk_bf16_f32 v42, v44, v45
    v_cvt_pk_bf16_f32 v43, v46, v47
    s_waitcnt lgkmcnt(13)
    v_mfma_f32_16x16x32_bf16 v[32:35], a[116:119], a[76:79], v[32:35]
    ds_read_b64_tr_b16 a[178:179], v237 offset:53248
    s_mov_b32 s55, 0
    v_mfma_f32_16x16x32_bf16 v[48:51], a[112:115], a[80:83], v[48:51]
    buffer_store_dwordx4 v[40:43], v244, s[76:79], s55 offen offset:0 sc1
    ds_read_b64_tr_b16 a[180:181], v237 offset:57344
    v_cvt_pk_bf16_f32 v58, v60, v61
    v_mfma_f32_16x16x32_bf16 v[48:51], a[116:119], a[84:87], v[48:51]
    v_cvt_pk_bf16_f32 v59, v62, v63
    s_mov_b32 s55, 0
    v_mfma_f32_16x16x32_bf16 v[64:67], a[112:115], a[88:91], v[64:67]
    buffer_store_dwordx4 v[56:59], v244, s[76:79], s55 offen offset:1024 sc1
    ds_read_b64_tr_b16 a[182:183], v237 offset:61440
    v_cvt_pk_bf16_f32 v74, v76, v77
    v_mfma_f32_16x16x32_bf16 v[64:67], a[116:119], a[92:95], v[64:67]
    ds_read_b64_tr_b16 a[184:185], v238 offset:49152
    v_cvt_pk_bf16_f32 v75, v78, v79
    s_mov_b32 s55, 0
    v_mfma_f32_16x16x32_bf16 v[80:83], a[112:115], a[96:99], v[80:83]
    buffer_store_dwordx4 v[72:75], v244, s[76:79], s55 offen offset:2048 sc1
    v_cvt_pk_bf16_f32 v90, v92, v93
    v_mfma_f32_16x16x32_bf16 v[80:83], a[116:119], a[100:103], v[80:83]
    ds_read_b64_tr_b16 a[186:187], v238 offset:53248
    v_cvt_pk_bf16_f32 v91, v94, v95
    s_mov_b32 s55, 0
    v_mfma_f32_16x16x32_bf16 v[96:99], a[112:115], a[104:107], v[96:99]
    buffer_store_dwordx4 v[88:91], v244, s[76:79], s55 offen offset:3072 sc1
    v_cvt_pk_bf16_f32 v106, v108, v109
    v_mfma_f32_16x16x32_bf16 v[96:99], a[116:119], a[108:111], v[96:99]
    v_cvt_pk_bf16_f32 v107, v110, v111
    s_mov_b32 s55, 4096
    buffer_store_dwordx4 v[104:107], v244, s[76:79], s55 offen offset:0 sc1
    s_waitcnt lgkmcnt(15)
    v_mfma_f32_16x16x32_bf16 v[36:39], a[120:123], a[72:75], v[36:39]
    ds_read_b64_tr_b16 a[188:189], v238 offset:57344
    ds_read_b64_tr_b16 a[190:191], v238 offset:61440
    s_waitcnt lgkmcnt(15)
    v_mfma_f32_16x16x32_bf16 v[36:39], a[124:127], a[76:79], v[36:39]
    v_mfma_f32_16x16x32_bf16 v[52:55], a[120:123], a[80:83], v[52:55]
    v_mfma_f32_16x16x32_bf16 v[52:55], a[124:127], a[84:87], v[52:55]
    v_mfma_f32_16x16x32_bf16 v[68:71], a[120:123], a[88:91], v[68:71]
    v_mfma_f32_16x16x32_bf16 v[68:71], a[124:127], a[92:95], v[68:71]
    v_mfma_f32_16x16x32_bf16 v[84:87], a[120:123], a[96:99], v[84:87]
    v_mfma_f32_16x16x32_bf16 v[84:87], a[124:127], a[100:103], v[84:87]
    v_mfma_f32_16x16x32_bf16 v[100:103], a[120:123], a[104:107], v[100:103]
    v_mfma_f32_16x16x32_bf16 v[100:103], a[124:127], a[108:111], v[100:103]
    s_waitcnt lgkmcnt(14)
    v_mfma_f32_16x16x32_bf16 v[32:35], a[144:147], a[208:211], v[32:35]
    s_waitcnt lgkmcnt(12)
    v_mfma_f32_16x16x32_bf16 v[32:35], a[148:151], a[212:215], v[32:35]
    v_mfma_f32_16x16x32_bf16 v[48:51], a[144:147], a[216:219], v[48:51]
    v_mfma_f32_16x16x32_bf16 v[48:51], a[148:151], a[220:223], v[48:51]
    v_mfma_f32_16x16x32_bf16 v[64:67], a[144:147], a[224:227], v[64:67]
    v_mfma_f32_16x16x32_bf16 v[64:67], a[148:151], a[228:231], v[64:67]
    v_mfma_f32_16x16x32_bf16 v[80:83], a[144:147], a[232:235], v[80:83]
    v_mfma_f32_16x16x32_bf16 v[80:83], a[148:151], a[236:239], v[80:83]
    v_mfma_f32_16x16x32_bf16 v[96:99], a[144:147], a[240:243], v[96:99]
    v_mfma_f32_16x16x32_bf16 v[96:99], a[148:151], a[244:247], v[96:99]
    s_waitcnt lgkmcnt(10)
    v_mfma_f32_16x16x32_bf16 v[36:39], a[152:155], a[208:211], v[36:39]
    s_waitcnt lgkmcnt(8)
    v_mfma_f32_16x16x32_bf16 v[36:39], a[156:159], a[212:215], v[36:39]
    v_mfma_f32_16x16x32_bf16 v[52:55], a[152:155], a[216:219], v[52:55]
    v_mfma_f32_16x16x32_bf16 v[52:55], a[156:159], a[220:223], v[52:55]
    v_mfma_f32_16x16x32_bf16 v[68:71], a[152:155], a[224:227], v[68:71]
    v_mfma_f32_16x16x32_bf16 v[68:71], a[156:159], a[228:231], v[68:71]
    v_mfma_f32_16x16x32_bf16 v[84:87], a[152:155], a[232:235], v[84:87]
    v_mfma_f32_16x16x32_bf16 v[84:87], a[156:159], a[236:239], v[84:87]
    v_mfma_f32_16x16x32_bf16 v[100:103], a[152:155], a[240:243], v[100:103]
    v_mfma_f32_16x16x32_bf16 v[100:103], a[156:159], a[244:247], v[100:103]
    s_waitcnt lgkmcnt(6)
    v_mfma_f32_16x16x32_bf16 v[32:35], a[176:179], a[32:35], v[32:35]
    s_waitcnt lgkmcnt(4)
    v_mfma_f32_16x16x32_bf16 v[32:35], a[180:183], a[36:39], v[32:35]
    v_mfma_f32_16x16x32_bf16 v[48:51], a[176:179], a[40:43], v[48:51]
    v_mfma_f32_16x16x32_bf16 v[48:51], a[180:183], a[44:47], v[48:51]
    v_mfma_f32_16x16x32_bf16 v[64:67], a[176:179], a[48:51], v[64:67]
    v_mfma_f32_16x16x32_bf16 v[64:67], a[180:183], a[52:55], v[64:67]
    s_waitcnt vmcnt(0)
    buffer_store_dword v27, v26, s[44:47], 0 offen sc1
    v_mfma_f32_16x16x32_bf16 v[80:83], a[176:179], a[56:59], v[80:83]
    v_mfma_f32_16x16x32_bf16 v[80:83], a[180:183], a[60:63], v[80:83]
    v_mfma_f32_16x16x32_bf16 v[96:99], a[176:179], a[64:67], v[96:99]
    v_mfma_f32_16x16x32_bf16 v[96:99], a[180:183], a[68:71], v[96:99]
    s_waitcnt lgkmcnt(2)
    v_mfma_f32_16x16x32_bf16 v[36:39], a[184:187], a[32:35], v[36:39]
    s_waitcnt lgkmcnt(0)
    v_mfma_f32_16x16x32_bf16 v[36:39], a[188:191], a[36:39], v[36:39]
    v_mfma_f32_16x16x32_bf16 v[52:55], a[184:187], a[40:43], v[52:55]
    v_mfma_f32_16x16x32_bf16 v[52:55], a[188:191], a[44:47], v[52:55]
    v_mfma_f32_16x16x32_bf16 v[68:71], a[184:187], a[48:51], v[68:71]
    v_mfma_f32_16x16x32_bf16 v[68:71], a[188:191], a[52:55], v[68:71]
    v_mfma_f32_16x16x32_bf16 v[84:87], a[184:187], a[56:59], v[84:87]
    v_mfma_f32_16x16x32_bf16 v[84:87], a[188:191], a[60:63], v[84:87]
    v_mfma_f32_16x16x32_bf16 v[100:103], a[184:187], a[64:67], v[100:103]
    buffer_load_dword v28, off, s[44:47], s92 sc1
    v_mfma_f32_16x16x32_bf16 v[100:103], a[188:191], a[68:71], v[100:103]
    s_branch Lex_test
Lex_poll:
    buffer_load_dword v28, off, s[44:47], s92 sc1
Lex_test:
    s_sub_u32 s82, s82, 1
    s_cbranch_scc1 Lex_done
    s_waitcnt vmcnt(0)
    v_readfirstlane_b32 s62, v28
    s_nop 1
    s_cmp_lg_u32 s62, 1
    s_cbranch_scc1 Lex_poll
Lex_done:
    s_mov_b32 s55, 0
    buffer_load_dwordx4 v[112:115], v243, s[76:79], s55 offen offset:0 sc1
    buffer_load_dwordx4 v[116:119], v243, s[76:79], s55 offen offset:1024 sc1
    buffer_load_dwordx4 v[120:123], v243, s[76:79], s55 offen offset:2048 sc1
    buffer_load_dwordx4 v[124:127], v243, s[76:79], s55 offen offset:3072 sc1
    s_mov_b32 s55, 4096
    buffer_load_dwordx4 v[128:131], v243, s[76:79], s55 offen offset:0 sc1
    s_waitcnt vmcnt(4)
    v_lshlrev_b32 v26, 16, v112
    v_and_b32 v27, 0xffff0000, v112
    v_pk_add_f32 v[32:33], v[32:33], v[26:27]
    v_lshlrev_b32 v26, 16, v113
    v_and_b32 v27, 0xffff0000, v113
    v_pk_add_f32 v[34:35], v[34:35], v[26:27]
    v_lshlrev_b32 v26, 16, v114
    v_and_b32 v27, 0xffff0000, v114
    v_pk_add_f32 v[36:37], v[36:37], v[26:27]
    v_lshlrev_b32 v26, 16, v115
    v_and_b32 v27, 0xffff0000, v115
    v_pk_add_f32 v[38:39], v[38:39], v[26:27]
    v_cvt_pk_bf16_f32 v32, v32, v33
    v_cvt_pk_bf16_f32 v33, v34, v35
    v_cvt_pk_bf16_f32 v34, v36, v37
    v_cvt_pk_bf16_f32 v35, v38, v39
    s_mov_b32 s61, 0
    v_permlane16_swap_b32 v32, v34
    v_permlane16_swap_b32 v33, v35
    buffer_store_dwordx4 v[32:35], v245, s[32:35], s61 offen
    s_waitcnt vmcnt(4)
    v_lshlrev_b32 v26, 16, v116
    v_and_b32 v27, 0xffff0000, v116
    v_pk_add_f32 v[48:49], v[48:49], v[26:27]
    v_lshlrev_b32 v26, 16, v117
    v_and_b32 v27, 0xffff0000, v117
    v_pk_add_f32 v[50:51], v[50:51], v[26:27]
    v_lshlrev_b32 v26, 16, v118
    v_and_b32 v27, 0xffff0000, v118
    v_pk_add_f32 v[52:53], v[52:53], v[26:27]
    v_lshlrev_b32 v26, 16, v119
    v_and_b32 v27, 0xffff0000, v119
    v_pk_add_f32 v[54:55], v[54:55], v[26:27]
    v_cvt_pk_bf16_f32 v48, v48, v49
    v_cvt_pk_bf16_f32 v49, v50, v51
    v_cvt_pk_bf16_f32 v50, v52, v53
    v_cvt_pk_bf16_f32 v51, v54, v55
    s_mov_b32 s61, 65536
    v_permlane16_swap_b32 v48, v50
    v_permlane16_swap_b32 v49, v51
    buffer_store_dwordx4 v[48:51], v245, s[32:35], s61 offen
    s_waitcnt vmcnt(4)
    v_lshlrev_b32 v26, 16, v120
    v_and_b32 v27, 0xffff0000, v120
    v_pk_add_f32 v[64:65], v[64:65], v[26:27]
    v_lshlrev_b32 v26, 16, v121
    v_and_b32 v27, 0xffff0000, v121
    v_pk_add_f32 v[66:67], v[66:67], v[26:27]
    v_lshlrev_b32 v26, 16, v122
    v_and_b32 v27, 0xffff0000, v122
    v_pk_add_f32 v[68:69], v[68:69], v[26:27]
    v_lshlrev_b32 v26, 16, v123
    v_and_b32 v27, 0xffff0000, v123
    v_pk_add_f32 v[70:71], v[70:71], v[26:27]
    v_cvt_pk_bf16_f32 v64, v64, v65
    v_cvt_pk_bf16_f32 v65, v66, v67
    v_cvt_pk_bf16_f32 v66, v68, v69
    v_cvt_pk_bf16_f32 v67, v70, v71
    s_mov_b32 s61, 131072
    v_permlane16_swap_b32 v64, v66
    v_permlane16_swap_b32 v65, v67
    buffer_store_dwordx4 v[64:67], v245, s[32:35], s61 offen
    s_waitcnt vmcnt(4)
    v_lshlrev_b32 v26, 16, v124
    v_and_b32 v27, 0xffff0000, v124
    v_pk_add_f32 v[80:81], v[80:81], v[26:27]
    v_lshlrev_b32 v26, 16, v125
    v_and_b32 v27, 0xffff0000, v125
    v_pk_add_f32 v[82:83], v[82:83], v[26:27]
    v_lshlrev_b32 v26, 16, v126
    v_and_b32 v27, 0xffff0000, v126
    v_pk_add_f32 v[84:85], v[84:85], v[26:27]
    v_lshlrev_b32 v26, 16, v127
    v_and_b32 v27, 0xffff0000, v127
    v_pk_add_f32 v[86:87], v[86:87], v[26:27]
    v_cvt_pk_bf16_f32 v80, v80, v81
    v_cvt_pk_bf16_f32 v81, v82, v83
    v_cvt_pk_bf16_f32 v82, v84, v85
    v_cvt_pk_bf16_f32 v83, v86, v87
    s_mov_b32 s61, 196608
    v_permlane16_swap_b32 v80, v82
    v_permlane16_swap_b32 v81, v83
    buffer_store_dwordx4 v[80:83], v245, s[32:35], s61 offen
    s_waitcnt vmcnt(4)
    v_lshlrev_b32 v26, 16, v128
    v_and_b32 v27, 0xffff0000, v128
    v_pk_add_f32 v[96:97], v[96:97], v[26:27]
    v_lshlrev_b32 v26, 16, v129
    v_and_b32 v27, 0xffff0000, v129
    v_pk_add_f32 v[98:99], v[98:99], v[26:27]
    v_lshlrev_b32 v26, 16, v130
    v_and_b32 v27, 0xffff0000, v130
    v_pk_add_f32 v[100:101], v[100:101], v[26:27]
    v_lshlrev_b32 v26, 16, v131
    v_and_b32 v27, 0xffff0000, v131
    v_pk_add_f32 v[102:103], v[102:103], v[26:27]
    v_cvt_pk_bf16_f32 v96, v96, v97
    v_cvt_pk_bf16_f32 v97, v98, v99
    v_cvt_pk_bf16_f32 v98, v100, v101
    v_cvt_pk_bf16_f32 v99, v102, v103
    s_mov_b32 s61, 262144
    v_permlane16_swap_b32 v96, v98
    v_permlane16_swap_b32 v97, v99
    buffer_store_dwordx4 v[96:99], v245, s[32:35], s61 offen
Lexit1:
    s_endpgm
Lini_wait:
    s_mov_b32 s82, 32768
Lini_poll:
    buffer_load_dwordx4 v[248:251], off, s[36:39], s7 sc1
    s_waitcnt vmcnt(0)
    v_and_b32 v26, v248, v249
    v_and_b32 v28, v250, v251
    v_and_b32 v26, v26, v28
    s_sub_u32 s82, s82, 1
    s_cbranch_scc1 Lini_ok
    v_readfirstlane_b32 s63, v26
    s_nop 1
    s_cmp_lg_u32 s63, 0x01010101
    s_cbranch_scc1 Lini_poll
    s_branch Lini_ok
Lgrp_wait:
    s_mov_b32 s82, 32768
Lgrp_poll:
    buffer_load_dword v28, v247, s[44:47], 0 offen sc1
    s_sub_u32 s82, s82, 1
    s_cbranch_scc1 Lgrp_ok
    s_waitcnt vmcnt(0)
    v_cmp_eq_u32 vcc, 1, v28
    s_nop 4
    s_andn2_b32 s61, s101, vcc_lo
    s_cbranch_scc0 Lgrp_ok
    s_sleep 4
    s_branch Lgrp_poll
Lfallback:
    s_waitcnt lgkmcnt(0)
    s_mov_b32 s94, 1
    s_mov_b32 s92, 0
    v_and_b32 v7, 0xffff, v7
    v_and_b32 v8, 0xffff, v8
    v_and_b32 v9, 0xffff, v9
    v_and_b32 v10, 0xffff, v10
    v_and_b32 v11, 0xffff, v11
    v_and_b32 v12, 0xffff, v12
    v_and_b32 v13, 0xffff, v13
    v_and_b32 v14, 0xffff, v14
    v_and_b32 v15, 0xffff, v15
    v_and_b32 v16, 0xffff, v16
    v_and_b32 v17, 0xffff, v17
    v_and_b32 v18, 0xffff, v18
Lfb_loop:
    s_barrier
    s_mov_b32 m0, s95
    s_nop 0
    buffer_load_dwordx4 v1, s[16:19], s92 offen offset:0 lds
    buffer_load_dwordx4 v2, s[16:19], s92 offen offset:1024 lds
    buffer_load_dwordx4 v3, s[16:19], s92 offen offset:2048 lds
    buffer_load_dwordx4 v4, s[16:19], s92 offen offset:3072 lds
    s_waitcnt vmcnt(0)
    s_barrier
    ds_read_b128 a[184:187], v7 offset:0
    ds_read_b128 a[188:191], v8 offset:0
    ds_read_b128 a[192:195], v9 offset:0
    ds_read_b128 a[196:199], v10 offset:0
    ds_read_b128 a[200:203], v7 offset:4096
    ds_read_b128 a[204:207], v8 offset:4096
    ds_read_b128 a[208:211], v9 offset:4096
    ds_read_b128 a[212:215], v10 offset:4096
    s_waitcnt lgkmcnt(7)
    v_mfma_f32_16x16x32_bf16 v[228:231], a[184:187], a[104:107], 0
    s_waitcnt lgkmcnt(6)
    v_mfma_f32_16x16x32_bf16 v[228:231], a[188:191], a[108:111], v[228:231]
    s_waitcnt lgkmcnt(5)
    v_mfma_f32_16x16x32_bf16 v[228:231], a[192:195], a[112:115], v[228:231]
    s_waitcnt lgkmcnt(4)
    v_mfma_f32_16x16x32_bf16 v[228:231], a[196:199], a[116:119], v[228:231]
    s_waitcnt lgkmcnt(3)
    v_mfma_f32_16x16x32_bf16 v[232:235], a[200:203], a[104:107], 0
    s_waitcnt lgkmcnt(2)
    v_mfma_f32_16x16x32_bf16 v[232:235], a[204:207], a[108:111], v[232:235]
    s_waitcnt lgkmcnt(1)
    v_mfma_f32_16x16x32_bf16 v[232:235], a[208:211], a[112:115], v[232:235]
    s_waitcnt lgkmcnt(0)
    v_mfma_f32_16x16x32_bf16 v[232:235], a[212:215], a[116:119], v[232:235]
    v_mfma_f32_16x16x32_bf16 v[236:239], a[184:187], a[120:123], 0
    v_mfma_f32_16x16x32_bf16 v[236:239], a[188:191], a[124:127], v[236:239]
    v_mfma_f32_16x16x32_bf16 v[236:239], a[192:195], a[128:131], v[236:239]
    v_mfma_f32_16x16x32_bf16 v[236:239], a[196:199], a[132:135], v[236:239]
    v_mfma_f32_16x16x32_bf16 v[240:243], a[200:203], a[120:123], 0
    v_mfma_f32_16x16x32_bf16 v[240:243], a[204:207], a[124:127], v[240:243]
    v_mfma_f32_16x16x32_bf16 v[240:243], a[208:211], a[128:131], v[240:243]
    v_mfma_f32_16x16x32_bf16 v[240:243], a[212:215], a[132:135], v[240:243]
    v_mfma_f32_16x16x32_bf16 v[244:247], a[184:187], a[136:139], 0
    v_mfma_f32_16x16x32_bf16 v[244:247], a[188:191], a[140:143], v[244:247]
    v_mfma_f32_16x16x32_bf16 v[244:247], a[192:195], a[144:147], v[244:247]
    v_mfma_f32_16x16x32_bf16 v[244:247], a[196:199], a[148:151], v[244:247]
    v_mfma_f32_16x16x32_bf16 v[248:251], a[200:203], a[136:139], 0
    v_mfma_f32_16x16x32_bf16 v[248:251], a[204:207], a[140:143], v[248:251]
    v_mfma_f32_16x16x32_bf16 v[248:251], a[208:211], a[144:147], v[248:251]
    v_mfma_f32_16x16x32_bf16 v[248:251], a[212:215], a[148:151], v[248:251]
    v_mfma_f32_16x16x32_bf16 v[200:203], a[184:187], a[152:155], 0
    v_mfma_f32_16x16x32_bf16 v[200:203], a[188:191], a[156:159], v[200:203]
    v_mfma_f32_16x16x32_bf16 v[200:203], a[192:195], a[160:163], v[200:203]
    v_mfma_f32_16x16x32_bf16 v[200:203], a[196:199], a[164:167], v[200:203]
    v_mfma_f32_16x16x32_bf16 v[204:207], a[200:203], a[152:155], 0
    v_mfma_f32_16x16x32_bf16 v[204:207], a[204:207], a[156:159], v[204:207]
    v_mfma_f32_16x16x32_bf16 v[204:207], a[208:211], a[160:163], v[204:207]
    v_mfma_f32_16x16x32_bf16 v[204:207], a[212:215], a[164:167], v[204:207]
    v_mfma_f32_16x16x32_bf16 v[192:195], a[184:187], a[168:171], 0
    v_mfma_f32_16x16x32_bf16 v[192:195], a[188:191], a[172:175], v[192:195]
    v_mfma_f32_16x16x32_bf16 v[192:195], a[192:195], a[176:179], v[192:195]
    v_mfma_f32_16x16x32_bf16 v[192:195], a[196:199], a[180:183], v[192:195]
    v_mfma_f32_16x16x32_bf16 v[196:199], a[200:203], a[168:171], 0
    v_mfma_f32_16x16x32_bf16 v[196:199], a[204:207], a[172:175], v[196:199]
    v_mfma_f32_16x16x32_bf16 v[196:199], a[208:211], a[176:179], v[196:199]
    v_mfma_f32_16x16x32_bf16 v[196:199], a[212:215], a[180:183], v[196:199]
    v_max3_f32 v19, v19, v228, v229
    v_max3_f32 v19, v19, v230, v231
    v_max3_f32 v19, v19, v232, v233
    v_max3_f32 v19, v19, v234, v235
    v_max3_f32 v20, v20, v236, v237
    v_max3_f32 v20, v20, v238, v239
    v_max3_f32 v20, v20, v240, v241
    v_max3_f32 v20, v20, v242, v243
    v_max3_f32 v21, v21, v244, v245
    v_max3_f32 v21, v21, v246, v247
    v_max3_f32 v21, v21, v248, v249
    v_max3_f32 v21, v21, v250, v251
    v_max3_f32 v22, v22, v200, v201
    v_max3_f32 v22, v22, v202, v203
    v_max3_f32 v22, v22, v204, v205
    v_max3_f32 v22, v22, v206, v207
    v_max3_f32 v23, v23, v192, v193
    v_max3_f32 v23, v23, v194, v195
    v_max3_f32 v23, v23, v196, v197
    v_max3_f32 v23, v23, v198, v199
    s_addk_i32 s92, 0x2000
    s_cmp_lt_u32 s92, 131072
    s_cbranch_scc1 Lfb_loop
    s_barrier
    s_xor_b32 s92, s64, 0
    s_add_u32 m0, s95, 65536
    s_nop 0
    buffer_load_dwordx4 v1, s[16:19], s92 offen offset:0 nt lds
    buffer_load_dwordx4 v2, s[16:19], s92 offen offset:1024 nt lds
    buffer_load_dwordx4 v3, s[16:19], s92 offen offset:2048 nt lds
    buffer_load_dwordx4 v4, s[16:19], s92 offen offset:3072 nt lds
    s_add_u32 m0, s95, 81920
    s_nop 0
    buffer_load_dwordx4 v5, s[20:23], s92 offen offset:0 nt lds
    buffer_load_dwordx4 v6, s[20:23], s92 offen offset:1024 nt lds
    buffer_load_dwordx4 v5, s[20:23], s92 offen offset:2048 nt lds
    buffer_load_dwordx4 v6, s[20:23], s92 offen offset:3072 nt lds
    s_xor_b32 s92, s64, 8192
    s_add_u32 m0, s95, 98304
    s_nop 0
    buffer_load_dwordx4 v1, s[16:19], s92 offen offset:0 nt lds
    buffer_load_dwordx4 v2, s[16:19], s92 offen offset:1024 nt lds
    buffer_load_dwordx4 v3, s[16:19], s92 offen offset:2048 nt lds
    buffer_load_dwordx4 v4, s[16:19], s92 offen offset:3072 nt lds
    s_add_u32 m0, s95, 114688
    s_nop 0
    buffer_load_dwordx4 v5, s[20:23], s92 offen offset:0 nt lds
    buffer_load_dwordx4 v6, s[20:23], s92 offen offset:1024 nt lds
    buffer_load_dwordx4 v5, s[20:23], s92 offen offset:2048 nt lds
    buffer_load_dwordx4 v6, s[20:23], s92 offen offset:3072 nt lds
    s_xor_b32 s92, s64, 16384
    s_add_u32 m0, s95, 0
    s_nop 0
    buffer_load_dwordx4 v1, s[16:19], s92 offen offset:0 nt lds
    buffer_load_dwordx4 v2, s[16:19], s92 offen offset:1024 nt lds
    buffer_load_dwordx4 v3, s[16:19], s92 offen offset:2048 nt lds
    buffer_load_dwordx4 v4, s[16:19], s92 offen offset:3072 nt lds
    s_add_u32 m0, s95, 16384
    s_nop 0
    buffer_load_dwordx4 v5, s[20:23], s92 offen offset:0 nt lds
    buffer_load_dwordx4 v6, s[20:23], s92 offen offset:1024 nt lds
    buffer_load_dwordx4 v5, s[20:23], s92 offen offset:2048 nt lds
    buffer_load_dwordx4 v6, s[20:23], s92 offen offset:3072 nt lds
    s_xor_b32 s92, s64, 24576
    s_add_u32 m0, s95, 32768
    s_nop 0
    buffer_load_dwordx4 v1, s[16:19], s92 offen offset:0 nt lds
    buffer_load_dwordx4 v2, s[16:19], s92 offen offset:1024 nt lds
    buffer_load_dwordx4 v3, s[16:19], s92 offen offset:2048 nt lds
    buffer_load_dwordx4 v4, s[16:19], s92 offen offset:3072 nt lds
    v_or_b32 v7, 0x10000, v7
    v_or_b32 v8, 0x10000, v8
    v_or_b32 v9, 0x10000, v9
    v_or_b32 v10, 0x10000, v10
    v_or_b32 v11, 0x10000, v11
    v_or_b32 v12, 0x10000, v12
    v_or_b32 v13, 0x10000, v13
    v_or_b32 v14, 0x10000, v14
    v_or_b32 v15, 0x10000, v15
    v_or_b32 v16, 0x10000, v16
    v_or_b32 v17, 0x10000, v17
    v_or_b32 v18, 0x10000, v18
    s_waitcnt vmcnt(24)
    s_barrier
    ds_read_b128 a[184:187], v7 offset:0
    ds_read_b128 a[188:191], v8 offset:0
    ds_read_b128 a[192:195], v9 offset:0
    ds_read_b128 a[196:199], v10 offset:0
    ds_read_b128 a[200:203], v7 offset:4096
    ds_read_b128 a[204:207], v8 offset:4096
    ds_read_b128 a[208:211], v9 offset:4096
    ds_read_b128 a[212:215], v10 offset:4096
    s_mov_b32 s80, 32768
    s_mov_b32 s81, 65536
    s_mov_b32 s7, 0
    s_mov_b32 s3, 0xffffc040
    s_waitcnt vmcnt(16) lgkmcnt(0)
    s_barrier
    v_mfma_f32_16x16x32_bf16 v[228:231], a[184:187], a[104:107], 0
    v_mfma_f32_16x16x32_bf16 v[228:231], a[188:191], a[108:111], v[228:231]
    ds_read_b64_tr_b16 a[216:217], v11 offset:0
    s_sub_u32 s63, s80, 0x2000
    v_mfma_f32_16x16x32_bf16 v[228:231], a[192:195], a[112:115], v[228:231]
    v_mfma_f32_16x16x32_bf16 v[228:231], a[196:199], a[116:119], v[228:231]
    ds_read_b64_tr_b16 a[218:219], v11 offset:4096
    s_xor_b32 s63, s63, s64
    v_mfma_f32_16x16x32_bf16 v[232:235], a[200:203], a[104:107], 0
    v_mfma_f32_16x16x32_bf16 v[232:235], a[204:207], a[108:111], v[232:235]
    ds_read_b64_tr_b16 a[220:221], v12 offset:0
    v_mfma_f32_16x16x32_bf16 v[232:235], a[208:211], a[112:115], v[232:235]
    s_xor_b32 s62, s80, s64
    v_mfma_f32_16x16x32_bf16 v[232:235], a[212:215], a[116:119], v[232:235]
    ds_read_b64_tr_b16 a[222:223], v12 offset:4096
    v_mfma_f32_16x16x32_bf16 v[236:239], a[184:187], a[120:123], 0
    v_mfma_f32_16x16x32_bf16 v[236:239], a[188:191], a[124:127], v[236:239]
    ds_read_b64_tr_b16 a[224:225], v13 offset:0
    s_add_u32 s61, s81, 98304
    v_mfma_f32_16x16x32_bf16 v[236:239], a[192:195], a[128:131], v[236:239]
    v_max3_f32 v28, v228, v229, v230
    s_nop 0
    v_max3_f32 v29, v231, v232, v233
    v_mfma_f32_16x16x32_bf16 v[236:239], a[196:199], a[132:135], v[236:239]
    s_bitcmp0_b32 s3, s7
    s_cselect_b32 s55, s63, 0x40000000
    s_cselect_b32 s92, s62, 0x40000000
    v_mfma_f32_16x16x32_bf16 v[240:243], a[200:203], a[120:123], 0
    v_max3_f32 v28, v28, v234, v235
    v_max3_f32 v28, v28, v29, v19
    v_mfma_f32_16x16x32_bf16 v[240:243], a[204:207], a[124:127], v[240:243]
    ds_read_b64_tr_b16 a[226:227], v13 offset:4096
    v_mov_b32 v29, v28
    v_mfma_f32_16x16x32_bf16 v[240:243], a[208:211], a[128:131], v[240:243]
    ds_read_b64_tr_b16 a[228:229], v14 offset:0
    s_and_b32 s61, s61, 0x1ffff
    v_mfma_f32_16x16x32_bf16 v[240:243], a[212:215], a[132:135], v[240:243]
    v_permlane16_swap_b32 v28, v29
    v_mfma_f32_16x16x32_bf16 v[244:247], a[184:187], a[136:139], 0
    v_max_f32 v28, v28, v29
    v_mov_b32 v29, v28
    v_mfma_f32_16x16x32_bf16 v[244:247], a[188:191], a[140:143], v[244:247]
    ds_read_b64_tr_b16 a[230:231], v14 offset:4096
    s_add_u32 s61, s61, s95
    v_mfma_f32_16x16x32_bf16 v[244:247], a[192:195], a[144:147], v[244:247]
    ds_read_b64_tr_b16 a[232:233], v15 offset:0
    v_permlane32_swap_b32 v28, v29
    v_mfma_f32_16x16x32_bf16 v[244:247], a[196:199], a[148:151], v[244:247]
    ds_read_b64_tr_b16 a[234:235], v15 offset:4096
    s_add_u32 m0, s61, 16384
    v_max_f32 v28, v28, v29
    v_mfma_f32_16x16x32_bf16 v[248:251], a[200:203], a[136:139], 0
    v_sub_f32 v228, v228, v28
    v_sub_f32 v229, v229, v28
    v_mfma_f32_16x16x32_bf16 v[248:251], a[204:207], a[140:143], v[248:251]
    ds_read_b64_tr_b16 a[236:237], v16 offset:0
    v_sub_f32 v230, v230, v28
    v_sub_f32 v231, v231, v28
    v_mfma_f32_16x16x32_bf16 v[248:251], a[208:211], a[144:147], v[248:251]
    s_waitcnt vmcnt(6)
    buffer_load_dwordx4 v5, s[20:23], s55 offen offset:0 nt lds
    v_mfma_f32_16x16x32_bf16 v[248:251], a[212:215], a[148:151], v[248:251]
    ds_read_b64_tr_b16 a[238:239], v16 offset:4096
    v_sub_f32 v232, v232, v28
    v_sub_f32 v233, v233, v28
    v_mfma_f32_16x16x32_bf16 v[200:203], a[184:187], a[152:155], 0
    v_sub_f32 v234, v234, v28
    v_sub_f32 v235, v235, v28
    v_mfma_f32_16x16x32_bf16 v[200:203], a[188:191], a[156:159], v[200:203]
    s_waitcnt vmcnt(6)
    buffer_load_dwordx4 v6, s[20:23], s55 offen offset:1024 nt lds
    ds_read_b64_tr_b16 a[240:241], v17 offset:0
    v_mfma_f32_16x16x32_bf16 v[200:203], a[192:195], a[160:163], v[200:203]
    v_sub_f32 v208, 0, v28
    v_sub_f32 v209, 0, v28
    v_mfma_f32_16x16x32_bf16 v[200:203], a[196:199], a[164:167], v[200:203]
    s_waitcnt vmcnt(6)
    buffer_load_dwordx4 v5, s[20:23], s55 offen offset:2048 nt lds
    ds_read_b64_tr_b16 a[242:243], v17 offset:4096
    v_mfma_f32_16x16x32_bf16 v[204:207], a[200:203], a[152:155], 0
    v_sub_f32 v210, 0, v28
    v_sub_f32 v211, 0, v28
    v_mfma_f32_16x16x32_bf16 v[204:207], a[204:207], a[156:159], v[204:207]
    ds_read_b64_tr_b16 a[244:245], v18 offset:0
    v_exp_f32 v228, v228
    v_mfma_f32_16x16x32_bf16 v[204:207], a[208:211], a[160:163], v[204:207]
    s_waitcnt vmcnt(6)
    buffer_load_dwordx4 v6, s[20:23], s55 offen offset:3072 nt lds
    v_exp_f32 v229, v229
    v_mfma_f32_16x16x32_bf16 v[204:207], a[212:215], a[164:167], v[204:207]
    ds_read_b64_tr_b16 a[246:247], v18 offset:4096
    v_exp_f32 v230, v230
    v_mfma_f32_16x16x32_bf16 v[192:195], a[184:187], a[168:171], 0
    v_cvt_pk_bf16_f32 v228, v228, v229
    v_exp_f32 v231, v231
    v_mfma_f32_16x16x32_bf16 v[192:195], a[188:191], a[172:175], v[192:195]
    s_cmp_lt_u32 s92, 131072
    s_cselect_b32 s92, s92, 0x40000000
    v_mfma_f32_16x16x32_bf16 v[192:195], a[192:195], a[176:179], v[192:195]
    ds_read_b128 a[0:3], v7 offset:32768
    v_exp_f32 v232, v232
    v_cvt_pk_bf16_f32 v229, v230, v231
    v_mov_b64 v[160:161], 0
    v_mfma_f32_16x16x32_bf16 v[192:195], a[196:199], a[180:183], v[192:195]
    s_add_u32 m0, s81, s95
    v_exp_f32 v233, v233
    v_mfma_f32_16x16x32_bf16 v[196:199], a[200:203], a[168:171], 0
    v_exp_f32 v234, v234
    v_mov_b64 v[162:163], 0
    v_mfma_f32_16x16x32_bf16 v[196:199], a[204:207], a[172:175], v[196:199]
    v_cvt_pk_bf16_f32 v230, v232, v233
    v_exp_f32 v235, v235
    s_nop 0
    v_cvt_pk_bf16_f32 v231, v234, v235
    v_max3_f32 v26, v236, v237, v238
    v_max3_f32 v27, v239, v240, v241
    v_mfma_f32_16x16x32_bf16 v[196:199], a[208:211], a[176:179], v[196:199]
    s_waitcnt vmcnt(6)
    buffer_load_dwordx4 v1, s[16:19], s92 offen offset:0 nt lds
    ds_read_b128 a[4:7], v8 offset:32768
    v_mov_b64 v[164:165], 0
    v_mfma_f32_16x16x32_bf16 v[196:199], a[212:215], a[180:183], v[196:199]
    v_max3_f32 v26, v26, v242, v243
    v_max3_f32 v26, v26, v27, v20
    v_mov_b32 v27, v26
    s_waitcnt lgkmcnt(15)
    v_mfma_f32_16x16x32_bf16 v[32:35], a[216:219], v[228:231], 0
    v_permlane16_swap_b32 v26, v27
    v_max_f32 v26, v26, v27
    v_mov_b32 v27, v26
    v_mov_b64 v[166:167], 0
    s_waitcnt lgkmcnt(14)
    v_mfma_f32_16x16x32_bf16 v[36:39], a[220:223], v[228:231], 0
    s_waitcnt vmcnt(6)
    buffer_load_dwordx4 v2, s[16:19], s92 offen offset:1024 nt lds
    ds_read_b128 a[8:11], v9 offset:32768
    v_permlane32_swap_b32 v26, v27
    v_max_f32 v26, v26, v27
    v_sub_f32 v236, v236, v26
    v_sub_f32 v237, v237, v26
    s_waitcnt lgkmcnt(13)
    v_mfma_f32_16x16x32_bf16 v[40:43], a[224:227], v[228:231], 0
    v_sub_f32 v238, v238, v26
    v_sub_f32 v239, v239, v26
    v_sub_f32 v240, v240, v26
    v_sub_f32 v241, v241, v26
    v_sub_f32 v242, v242, v26
    v_sub_f32 v243, v243, v26
    v_sub_f32 v212, 0, v26
    v_mov_b64 v[168:169], 0
    s_waitcnt lgkmcnt(11)
    v_mfma_f32_16x16x32_bf16 v[44:47], a[228:231], v[228:231], 0
    s_waitcnt vmcnt(6)
    buffer_load_dwordx4 v3, s[16:19], s92 offen offset:2048 nt lds
    s_waitcnt lgkmcnt(9)
    v_mfma_f32_16x16x32_bf16 v[48:51], a[232:235], v[228:231], 0
    v_sub_f32 v213, 0, v26
    v_sub_f32 v214, 0, v26
    v_sub_f32 v215, 0, v26
    v_mov_b64 v[170:171], 0
    s_waitcnt lgkmcnt(7)
    v_mfma_f32_16x16x32_bf16 v[52:55], a[236:239], v[228:231], 0
    ds_read_b128 a[12:15], v10 offset:32768
    v_exp_f32 v236, v236
    v_exp_f32 v237, v237
    v_exp_f32 v238, v238
    v_cvt_pk_bf16_f32 v236, v236, v237
    s_waitcnt lgkmcnt(6)
    v_mfma_f32_16x16x32_bf16 v[56:59], a[240:243], v[228:231], 0
    s_waitcnt vmcnt(6)
    buffer_load_dwordx4 v4, s[16:19], s92 offen offset:3072 nt lds
    v_exp_f32 v239, v239
    v_exp_f32 v240, v240
    v_cvt_pk_bf16_f32 v237, v238, v239
    v_exp_f32 v241, v241
    v_exp_f32 v242, v242
    v_cvt_pk_bf16_f32 v238, v240, v241
    v_exp_f32 v243, v243
    s_nop 0
    v_cvt_pk_bf16_f32 v239, v242, v243
    v_mov_b64 v[172:173], 0
    s_waitcnt lgkmcnt(4)
    v_mfma_f32_16x16x32_bf16 v[60:63], a[244:247], v[228:231], 0
    v_max3_f32 v28, v244, v245, v246
    v_max3_f32 v29, v247, v248, v249
    v_mfma_f32_16x16x32_bf16 a[64:67], a[248:251], v[228:231], 0
    ds_read_b128 a[16:19], v7 offset:36864
    v_max3_f32 v28, v28, v250, v251
    v_max3_f32 v28, v28, v29, v21
    v_mov_b32 v29, v28
    s_nop 1
    v_permlane16_swap_b32 v28, v29
    v_max_f32 v28, v28, v29
    v_mov_b32 v29, v28
    v_mfma_f32_16x16x32_bf16 v[64:67], a[216:219], v[236:239], 0
    s_bitcmp0_b32 s3, s7
    s_cselect_b32 s62, 0x2000, 0
    v_mov_b64 v[174:175], 0
    v_mfma_f32_16x16x32_bf16 v[68:71], a[220:223], v[236:239], 0
    v_permlane32_swap_b32 v28, v29
    v_max_f32 v28, v28, v29
    v_sub_f32 v244, v244, v28
    v_sub_f32 v245, v245, v28
    v_mfma_f32_16x16x32_bf16 v[72:75], a[224:227], v[236:239], 0
    s_add_u32 s80, s80, s62
    v_sub_f32 v246, v246, v28
    v_sub_f32 v247, v247, v28
    v_sub_f32 v248, v248, v28
    v_mov_b64 v[176:177], 0
    v_mfma_f32_16x16x32_bf16 v[76:79], a[228:231], v[236:239], 0
    ds_read_b128 a[20:23], v8 offset:36864
    v_sub_f32 v249, v249, v28
    v_sub_f32 v250, v250, v28
    v_sub_f32 v251, v251, v28
    v_sub_f32 v216, 0, v28
    v_mfma_f32_16x16x32_bf16 v[80:83], a[232:235], v[236:239], 0
    v_sub_f32 v217, 0, v28
    v_sub_f32 v218, 0, v28
    v_sub_f32 v219, 0, v28
    v_mov_b64 v[178:179], 0
    v_mfma_f32_16x16x32_bf16 v[84:87], a[236:239], v[236:239], 0
    s_lshl2_add_u32 s81, s62, s81
    v_exp_f32 v244, v244
    v_exp_f32 v245, v245
    v_exp_f32 v246, v246
    v_mfma_f32_16x16x32_bf16 v[88:91], a[240:243], v[236:239], 0
    ds_read_b128 a[24:27], v9 offset:36864
    v_cvt_pk_bf16_f32 v244, v244, v245
    v_exp_f32 v247, v247
    v_exp_f32 v248, v248
    v_cvt_pk_bf16_f32 v245, v246, v247
    v_exp_f32 v249, v249
    v_exp_f32 v250, v250
    v_cvt_pk_bf16_f32 v246, v248, v249
    v_exp_f32 v251, v251
    s_nop 0
    v_cvt_pk_bf16_f32 v247, v250, v251
    v_mov_b64 v[180:181], 0
    v_mfma_f32_16x16x32_bf16 v[92:95], a[244:247], v[236:239], 0
    v_max3_f32 v26, v200, v201, v202
    v_max3_f32 v27, v203, v204, v205
    v_mfma_f32_16x16x32_bf16 a[68:71], a[248:251], v[236:239], 0
    s_and_b32 s81, s81, 0x1ffff
    v_max3_f32 v26, v26, v206, v207
    v_max3_f32 v26, v26, v27, v22
    v_mov_b32 v27, v26
    v_mov_b64 v[182:183], 0
    v_mfma_f32_16x16x32_bf16 v[96:99], a[216:219], v[244:247], 0
    v_permlane16_swap_b32 v26, v27
    v_max_f32 v26, v26, v27
    v_mov_b32 v27, v26
    v_mfma_f32_16x16x32_bf16 v[100:103], a[220:223], v[244:247], 0
    ds_read_b128 a[28:31], v10 offset:36864
    s_add_u32 s7, s7, 1
    v_permlane32_swap_b32 v26, v27
    v_max_f32 v26, v26, v27
    v_sub_f32 v200, v200, v26
    v_sub_f32 v201, v201, v26
    v_mov_b64 v[184:185], 0
    v_mfma_f32_16x16x32_bf16 v[104:107], a[224:227], v[244:247], 0
    v_sub_f32 v202, v202, v26
    v_sub_f32 v203, v203, v26
    v_sub_f32 v204, v204, v26
    v_mfma_f32_16x16x32_bf16 v[108:111], a[228:231], v[244:247], 0
    v_sub_f32 v205, v205, v26
    v_sub_f32 v206, v206, v26
    v_sub_f32 v207, v207, v26
    v_sub_f32 v220, 0, v26
    v_mfma_f32_16x16x32_bf16 v[112:115], a[232:235], v[244:247], 0
    v_sub_f32 v221, 0, v26
    v_sub_f32 v222, 0, v26
    v_sub_f32 v223, 0, v26
    v_mov_b64 v[186:187], 0
    v_mfma_f32_16x16x32_bf16 v[116:119], a[236:239], v[244:247], 0
    v_exp_f32 v200, v200
    v_exp_f32 v201, v201
    v_exp_f32 v202, v202
    v_xor_b32 v7, 0x10000, v7
    v_mfma_f32_16x16x32_bf16 v[120:123], a[240:243], v[244:247], 0
    v_cvt_pk_bf16_f32 v200, v200, v201
    v_exp_f32 v203, v203
    v_exp_f32 v204, v204
    v_cvt_pk_bf16_f32 v201, v202, v203
    v_exp_f32 v205, v205
    v_exp_f32 v206, v206
    v_cvt_pk_bf16_f32 v202, v204, v205
    v_exp_f32 v207, v207
    s_nop 0
    v_cvt_pk_bf16_f32 v203, v206, v207
    v_mov_b64 v[188:189], 0
    v_mfma_f32_16x16x32_bf16 v[124:127], a[244:247], v[244:247], 0
    v_max3_f32 v28, v192, v193, v194
    v_max3_f32 v29, v195, v196, v197
    v_mfma_f32_16x16x32_bf16 a[72:75], a[248:251], v[244:247], 0
    v_max3_f32 v28, v28, v198, v199
    v_max3_f32 v28, v28, v29, v23
    v_mov_b64 v[190:191], 0
    v_mfma_f32_16x16x32_bf16 v[128:131], a[216:219], v[200:203], 0
    v_mov_b32 v29, v28
    s_nop 1
    v_permlane16_swap_b32 v28, v29
    v_xor_b32 v8, 0x10000, v8
    v_mfma_f32_16x16x32_bf16 v[132:135], a[220:223], v[200:203], 0
    v_max_f32 v28, v28, v29
    v_mov_b32 v29, v28
    v_accvgpr_write_b32 a80, 0
    v_mfma_f32_16x16x32_bf16 v[136:139], a[224:227], v[200:203], 0
    v_permlane32_swap_b32 v28, v29
    v_max_f32 v28, v28, v29
    v_mfma_f32_16x16x32_bf16 v[140:143], a[228:231], v[200:203], 0
    v_sub_f32 v192, v192, v28
    v_sub_f32 v193, v193, v28
    v_sub_f32 v194, v194, v28
    v_accvgpr_write_b32 a81, 0
    v_xor_b32 v9, 0x10000, v9
    v_mfma_f32_16x16x32_bf16 v[144:147], a[232:235], v[200:203], 0
    v_sub_f32 v195, v195, v28
    v_sub_f32 v196, v196, v28
    v_mfma_f32_16x16x32_bf16 v[148:151], a[236:239], v[200:203], 0
    v_sub_f32 v197, v197, v28
    v_sub_f32 v198, v198, v28
    v_accvgpr_write_b32 a82, 0
    v_mfma_f32_16x16x32_bf16 v[152:155], a[240:243], v[200:203], 0
    v_sub_f32 v199, v199, v28
    v_sub_f32 v224, 0, v28
    v_sub_f32 v225, 0, v28
    v_mfma_f32_16x16x32_bf16 v[156:159], a[244:247], v[200:203], 0
    v_sub_f32 v226, 0, v28
    v_sub_f32 v227, 0, v28
    v_accvgpr_write_b32 a83, 0
    v_xor_b32 v10, 0x10000, v10
    v_mfma_f32_16x16x32_bf16 a[76:79], a[248:251], v[200:203], 0
    v_exp_f32 v192, v192
    v_exp_f32 v193, v193
    v_exp_f32 v194, v194
    v_cvt_pk_bf16_f32 v192, v192, v193
    v_exp_f32 v195, v195
    v_exp_f32 v196, v196
    v_lshrrev_b32 v228, 4, v0
    v_lshlrev_b32 v229, 1, v228
    v_xor_b32 v229, v229, v0
    v_and_b32 v229, 15, v229
    s_lshl_b32 s61, s4, 15
    v_lshl_add_u32 v228, v228, 11, s61
    v_lshl_add_u32 v228, v229, 4, v228
    v_xor_b32 v229, 128, v228
    v_add_u32 v230, 14336, v228
    v_add_u32 v231, 21504, v229
    v_add_u32 v229, 7168, v229
    v_lshlrev_b32 v26, 4, v0
    s_mul_i32 s61, s4, 5
    s_mul_i32 s90, s4, 5120
    s_add_u32 s62, s61, 0
    s_lshr_b32 s63, s62, 1
    s_lshl_b32 s63, s63, 7
    s_and_b32 s62, s62, 1
    s_add_u32 s62, s62, s63
    s_sub_u32 s62, s62, 0
    s_lshl_b32 s62, s62, 10
    v_add_u32 v232, s62, v26
    s_add_u32 s62, s61, 1
    s_lshr_b32 s63, s62, 1
    s_lshl_b32 s63, s63, 7
    s_and_b32 s62, s62, 1
    s_add_u32 s62, s62, s63
    s_sub_u32 s62, s62, 1
    s_lshl_b32 s62, s62, 10
    v_add_u32 v233, s62, v26
    s_add_u32 s62, s61, 2
    s_lshr_b32 s63, s62, 1
    s_lshl_b32 s63, s63, 7
    s_and_b32 s62, s62, 1
    s_add_u32 s62, s62, s63
    s_sub_u32 s62, s62, 2
    s_lshl_b32 s62, s62, 10
    v_add_u32 v234, s62, v26
    s_add_u32 s62, s61, 3
    s_lshr_b32 s63, s62, 1
    s_lshl_b32 s63, s63, 7
    s_and_b32 s62, s62, 1
    s_add_u32 s62, s62, s63
    s_sub_u32 s62, s62, 3
    s_lshl_b32 s62, s62, 10
    v_add_u32 v235, s62, v26
    s_add_u32 s62, s61, 4
    s_lshr_b32 s63, s62, 1
    s_lshl_b32 s63, s63, 7
    s_and_b32 s62, s62, 1
    s_add_u32 s62, s62, s63
    s_sub_u32 s62, s62, 0
    s_lshl_b32 s62, s62, 10
    v_add_u32 v236, s62, v26
    s_mul_i32 s61, s6, 10240
    s_add_u32 s61, s61, 65536
    v_add_u32 v241, s61, v26
    v_add_u32 v242, 40960, v241
    s_xor_b32 s61, s2, 2
    s_lshl2_add_u32 s61, s61, s4
    s_mul_i32 s61, s61, 10240
    v_add_u32 v244, s61, v26
    s_lshl2_add_u32 s61, s2, s4
    s_mul_i32 s61, s61, 10240
    v_add_u32 v243, s61, v26
    v_lshrrev_b32 v26, 2, v0
    v_and_b32 v27, 7, v26
    v_lshlrev_b32 v26, 8, v26
    v_and_b32 v28, 3, v0
    v_lshl_add_u32 v26, v28, 3, v26
    s_lshl_b32 s61, s5, 2
    s_lshl1_add_u32 s61, s51, s61
    v_xor_b32 v27, s61, v27
    v_lshl_add_u32 v237, v27, 5, v26
    v_xor_b32 v238, 32, v237
    v_xor_b32 v239, 64, v237
    v_xor_b32 v240, 96, v237
    v_and_b32 v26, 15, v0
    s_mul_i32 s61, s6, 327680
    s_lshl_b32 s62, s5, 7
    s_add_u32 s61, s61, s62
    s_lshl_b32 s62, s51, 6
    s_add_u32 s61, s61, s62
    v_lshl_add_u32 v26, v26, 12, s61
    v_bfe_u32 v27, v0, 4, 1
    v_lshl_add_u32 v26, v27, 5, v26
    v_lshrrev_b32 v27, 5, v0
    v_lshl_add_u32 v245, v27, 4, v26
    v_and_b32 v26, 3, v0
    v_bfe_u32 v27, v0, 2, 2
    v_lshl_add_u32 v26, v26, 3, v27
    s_lshl_b32 s61, s49, 5
    s_lshl2_add_u32 s61, s48, s61
    s_lshl_b32 s61, s61, 5
    s_add_u32 s61, s61, s50
    s_lshl_b32 s61, s61, 2
    v_lshl_add_u32 v26, v26, 7, s61
    v_and_b32 v27, 48, v0
    v_lshl_add_u32 v246, v27, 24, v26
    s_lshl_b32 s61, s2, 7
    v_lshl_add_u32 v26, v0, 2, s61
    v_and_b32 v27, 48, v0
    v_lshl_add_u32 v26, v27, 24, v26
    v_mov_b32 v247, v26
    s_branch Lattn_loop
.section .rodata,"a"
.p2align 6
.amdhsa_kernel concat_heads__mha_block_cached__mha_block_cached__near_ridge_kernel
  .amdhsa_next_free_vgpr 512
  .amdhsa_next_free_sgpr 102
  .amdhsa_accum_offset 256
  .amdhsa_group_segment_fixed_size 0
  .amdhsa_kernarg_size 104
  .amdhsa_user_sgpr_count 2
  .amdhsa_user_sgpr_kernarg_segment_ptr 1
  .amdhsa_system_sgpr_workgroup_id_x 1
.end_amdhsa_kernel
```
